```python
import torch

def _softmax(x, axis=-1):
    return torch.softmax(x, dim=axis)
def _gelu(x):
    return torch.nn.functional.gelu(x, approximate="tanh")
def _silu(x):
    return torch.nn.functional.silu(x)
def _sigmoid(x):
    return torch.sigmoid(x)
def _layernorm(x, axis=-1, eps=1e-5):
    m = x.mean(dim=axis, keepdim=True)
    v = x.var(dim=axis, keepdim=True, unbiased=False)
    return (x - m) / torch.sqrt(v + eps)
def _scatter_add(tgt, idx, src, axis=0):
    return tgt.clone().index_add_(axis, idx, src)
def _segment_sum(src, seg, n):
    out = torch.zeros((n,) + src.shape[1:], dtype=src.dtype)
    return out.index_add_(0, seg, src)
def _pad(x, pw):
    flat = tuple(v for pair in reversed(pw) for v in pair)
    return torch.nn.functional.pad(x, flat)

kernel_name = 'concat_heads__sliding_block__ssm_conv_h3__prompt'

def setup_inputs():

    _w = (lambda a: (lambda t: t.to(torch.bfloat16) if t.is_floating_point() else t)(torch.as_tensor(a)))
    def _A_setup():
        B, S, D = 1, 2048, 576
        return {
            "x": _w((lambda *s: torch.randn(*s, dtype=torch.bfloat16) * 0.2)(B, S, D)),
            "wqkv": _w((lambda *s: torch.randn(*s, dtype=torch.bfloat16) * 0.2)(D, 3 * D)),
            "wo": _w((lambda *s: torch.randn(*s, dtype=torch.bfloat16) * 0.05)(D, D)),
        }
    _A_in = _A_setup()

    def _B_setup():
        B, S, D = 1, 2048, 576
        ks = 4
        return {
            "q": _w((lambda *s: torch.randn(*s, dtype=torch.bfloat16) * 0.05)(B, S, D)),
            "k": _w((lambda *s: torch.randn(*s, dtype=torch.bfloat16) * 0.8)(B, S, D)),
            "v": _w((lambda *s: torch.randn(*s, dtype=torch.bfloat16) * 0.8)(B, S, D)),
            "shift_k": _w((lambda *s: torch.randn(*s, dtype=torch.bfloat16) * 0.8)(D, ks) * 0.5),
            "ssm_k": _w((lambda *s: torch.randn(*s, dtype=torch.bfloat16) * 3.2)(D, S) * (1.0 / S ** 0.5)),
            "ssm_D": _w((lambda *s: torch.randn(*s, dtype=torch.bfloat16) * 0.8)(D)),
        }
    _B_in = _B_setup()

    return {
        "A_x": _A_in["x"],
        "A_wqkv": _A_in["wqkv"],
        "A_wo": _A_in["wo"],
        "B_q": _B_in["q"],
        "B_k": _B_in["k"],
        "B_v": _B_in["v"],
        "B_shift_k": _B_in["shift_k"],
        "B_ssm_k": _B_in["ssm_k"],
        "B_ssm_D": _B_in["ssm_D"],
    }

def reference(A_x, A_wqkv, A_wo, B_q, B_k, B_v, B_shift_k, B_ssm_k, B_ssm_D):
    def _A_ref(x, wqkv, wo):
        B, S, D = x.shape
        H = 32; Dh = D // H; W = 256
        qkv = (lambda x, *d: x.permute(*d))((x @ wqkv).reshape(B, S, 3, H, Dh), 2, 0, 3, 1, 4)
        q, k, v = qkv[0], qkv[1], qkv[2]
        scores = torch.einsum("bhqd,bhkd->bhqk", q, k) * (Dh ** -0.5)
        idx = torch.arange(S)
        mask = (idx[:, None] - idx[None, :] >= 0) & (idx[:, None] - idx[None, :] < W)
        scores = torch.where(mask[None, None], scores, -1e9)
        p = _softmax(scores, axis=-1)
        o = torch.einsum("bhqk,bhkd->bhqd", p, v)
        return (lambda x, *d: x.permute(*d))(o, 0, 2, 1, 3).reshape(B, S, D) @ wo

    def _B_ref(q, k, v, shift_k, ssm_k, ssm_D):
        B, S, D = q.shape
        ks = shift_k.shape[-1]
        k_pad = _pad(k, ((0, 0), (ks - 1, 0), (0, 0)))
        k_shift = torch.zeros_like(k)
        for t in range(ks):
            k_shift = k_shift + k_pad[:, t:t + S, :] * shift_k[:, ks - 1 - t][None, None, :]
        kv = k_shift * v
        L = 2 * S
        kv_pad = _pad(kv, ((0, 0), (0, S), (0, 0)))
        kf_pad = _pad(ssm_k, ((0, 0), (0, S)))
        kv_f = (lambda x, axes=(-2,-1): torch.fft.rfft2(x.float(), dim=axes))(kv_pad[:, None, :, :], axes=(1, 2))
        kf_f = (lambda x, axes=(-2,-1): torch.fft.rfft2(x.float(), dim=axes))(kf_pad[:, None, :], axes=(1, 2))
        kf_f = (lambda x, *d: x.permute(*d))(kf_f, 1, 2, 0)
        y_f = kv_f * kf_f[None, :, :, :]
        y = (lambda x, s, axes=(-2,-1): torch.fft.irfft2(x, s=s, dim=axes).to(torch.bfloat16))(y_f, (1, L), axes=(1, 2))[:, 0, :S, :]
        y = y + kv * ssm_D[None, None, :]
        return q * y

    a = _A_ref(A_x, A_wqkv, A_wo)
    b = _B_ref(B_q, B_k, B_v, B_shift_k, B_ssm_k, B_ssm_D)
    return torch.concatenate([a, b], axis=-1)
```

```asm
; @launch grid=(256,1,1) block=(768,1,1) lds=163840
.amdgcn_target "amdgcn-amd-amdhsa--gfx950"
.text
.set CODE_LAST, L_codeend - concat_heads__sliding_block__ssm_conv_h3__prompt_kernel - 128
.globl concat_heads__sliding_block__ssm_conv_h3__prompt_kernel
.p2align 8
.type concat_heads__sliding_block__ssm_conv_h3__prompt_kernel,@function
concat_heads__sliding_block__ssm_conv_h3__prompt_kernel:
    s_load_dwordx16 s[4:19], s[0:1], 0
    s_load_dwordx8 s[20:27], s[0:1], 64
    s_cmp_ge_u32 s2, 256
    s_cbranch_scc1 L_end
    s_lshr_b32 s93, s2, 3
    v_lshrrev_b32 v1, 6, v0
    s_getpc_b64 s[46:47]
    v_readfirstlane_b32 s44, v1
    v_and_b32 v2, 63, v0
    s_cmp_lg_u32 s44, 0
    s_cbranch_scc1 L_nopf
    v_and_b32 v1, 7, v0
    v_lshl_add_u32 v1, v1, 5, s93
    v_lshlrev_b32 v1, 7, v1
    v_min_u32 v1, CODE_LAST, v1
    global_load_dword v4, v1, s[46:47]
L_nopf:
    s_and_b32 s92, s2, 7
    s_cmp_ge_u32 s93, 28
    s_cselect_b32 s97, 1, 0
    s_cmp_ge_u32 s44, 8
    s_cbranch_scc1 L_h
    v_lshrrev_b32 v120, 3, v2
    v_and_b32 v121, 7, v2
    v_mul_u32_u24 v120, 1152, v120
    v_lshl_add_u32 v120, v121, 4, v120
    s_and_b32 s48, s2, 31
    s_lshl_b32 s48, s48, 3
    s_add_u32 s48, s48, s44
    s_mul_i32 s48, s48, 9216
    s_lshr_b32 s49, s2, 5
    s_lshl_b32 s50, s49, 7
    s_add_u32 s48, s48, s50
    v_add_u32 v120, s48, v120
    v_subrev_u32 v121, 9216, v120
    s_mul_i32 s51, s44, 3072
    v_and_b32 v122, 15, v2
    v_lshlrev_b32 v123, 5, v122
    s_lshl_b32 s52, s49, 9
    s_mov_b32 s34, 2359296
    s_mov_b32 s35, 0x20000
    s_mov_b32 s38, 2359296
    s_mov_b32 s39, 0x20000
    s_mov_b32 s42, 4608
    s_mov_b32 s43, 0x20000
    s_waitcnt lgkmcnt(0)
    s_mov_b32 s32, s12
    s_mov_b32 s33, s13
    s_mov_b32 s36, s14
    s_mov_b32 s37, s15
    s_mov_b32 s40, s16
    s_mov_b32 s41, s17
    s_add_u32 m0, s51, 99328
    s_nop 0
    buffer_load_dwordx4 v120, s[32:35], 0 offen offset:0  lds
    s_add_u32 m0, s51, 100352
    s_nop 0
    buffer_load_dwordx4 v120, s[36:39], 0 offen offset:0  lds
    s_add_u32 m0, s51, 98304
    s_mov_b32 exec_lo, 0
    s_mov_b32 exec_hi, 0xffffff00
    buffer_load_dwordx4 v121, s[32:35], 0 offen offset:0  lds
    s_mov_b64 exec, -1
    buffer_load_dwordx4 v[128:131], v123, s[40:43], s52 offen offset:0
    buffer_load_dwordx4 v[132:135], v123, s[40:43], s52 offen offset:16
    s_barrier
    s_branch L_crest
L_h:
    s_setprio 3
    s_sub_u32 s57, s44, 8
    v_subrev_u32 v20, 512, v0
    v_lshlrev_b32 v16, 2, v20
    v_add_u32 v16, 157184, v16
    v_mov_b32 v17, 0x3f803f80
    v_mov_b32 v18, 0
    ds_write_b32 v16, v17 offset:256
    ds_write_b32 v16, v17 offset:1280
    ds_write_b32 v16, v17 offset:2304
    ds_write_b32 v16, v17 offset:3328
    ds_write_b32 v16, v17 offset:4352
    s_cmp_lg_u32 s57, 0
    s_cbranch_scc1 L_hz
    ds_write_b32 v16, v18
L_hz:
    s_cmp_eq_u32 s97, 1
    s_cbranch_scc1 L_hidle
    s_mul_i32 s48, s93, 37
    s_lshr_b32 s48, s48, 8
    s_mul_i32 s49, s48, 7
    s_sub_u32 s49, s93, s49
    s_and_b32 s94, s92, 3
    s_lshl_b32 s94, s94, 2
    s_add_u32 s94, s94, s48
    s_lshr_b32 s95, s92, 2
    s_mul_i32 s95, s95, 7
    s_add_u32 s95, s95, s49
    s_mul_i32 s96, s48, 2
    s_mul_i32 s52, s49, 1
    s_add_u32 s96, s96, s52
    s_mul_i32 s52, s92, 0
    s_add_u32 s96, s96, s52
    s_mul_i32 s52, s96, 128
    s_lshr_b32 s52, s52, 10
    s_mul_i32 s52, s52, 8
    s_sub_u32 s96, s96, s52
    s_mov_b32 s62, 0x76543210
    s_mov_b32 s63, 8
    s_cmp_eq_u32 s96, 1
    s_cselect_b32 s62, 0x87654320, s62
    s_cselect_b32 s63, 1, s63
    s_cmp_eq_u32 s96, 2
    s_cselect_b32 s62, 0x18765430, s62
    s_cselect_b32 s63, 2, s63
    s_cmp_eq_u32 s96, 3
    s_cselect_b32 s62, 0x21876540, s62
    s_cselect_b32 s63, 3, s63
    s_cmp_eq_u32 s96, 4
    s_cselect_b32 s62, 0x32187650, s62
    s_cselect_b32 s63, 4, s63
    s_cmp_eq_u32 s96, 5
    s_cselect_b32 s62, 0x43218760, s62
    s_cselect_b32 s63, 5, s63
    s_cmp_eq_u32 s96, 6
    s_cselect_b32 s62, 0x54321870, s62
    s_cselect_b32 s63, 6, s63
    s_cmp_eq_u32 s96, 7
    s_cselect_b32 s62, 0x65432180, s62
    s_cselect_b32 s63, 7, s63
    v_lshrrev_b32 v16, 3, v2
    v_and_b32 v17, 7, v2
    v_bfe_u32 v18, v2, 4, 1
    v_xor_b32 v18, v18, v17
    v_mul_u32_u24 v8, 3456, v16
    v_lshl_add_u32 v8, v18, 4, v8
    s_lshl_b32 s47, s95, 8
    s_mul_i32 s48, s57, 55296
    s_add_u32 s47, s47, s48
    v_add_u32 v8, s47, v8
    v_xor_b32 v9, 64, v8
    v_add_u32 v9, 27648, v9
    v_lshrrev_b32 v18, 1, v16
    v_xor_b32 v18, v18, v17
    v_mul_u32_u24 v10, 1152, v16
    v_lshl_add_u32 v10, v18, 4, v10
    s_mul_i32 s48, s94, 147456
    s_mul_i32 s49, s57, 36864
    s_add_u32 s48, s48, s49
    v_add_u32 v10, s48, v10
    v_xor_b32 v11, 64, v10
    v_add_u32 v11, 9216, v11
    v_add_u32 v12, 18432, v10
    v_add_u32 v13, 18432, v11
    s_cmp_eq_u32 s95, 13
    s_cselect_b32 s48, 0x80000000, 0
    s_add_u32 s48, s48, 128
    v_add_u32 v14, s48, v8
    v_add_u32 v15, s48, v9
    s_lshl_b32 s49, s57, 11
    s_add_u32 s49, s49, 16384
    s_lshl_b32 s50, s57, 12
    s_mov_b32 s56, 0
    s_mov_b32 s55, 4294868992
    s_mov_b32 s34, 2359296
    s_mov_b32 s35, 0x20000
    s_mov_b32 s38, 1990656
    s_mov_b32 s39, 0x20000
    s_waitcnt lgkmcnt(0)
    s_mov_b32 s32, s4
    s_mov_b32 s33, s5
    s_mov_b32 s36, s6
    s_mov_b32 s37, s7
    s_barrier
    s_and_b32 s52, s62, 15
    s_mul_i32 s51, s52, 221184
    s_mov_b32 m0, s49
    s_lshl_b32 s52, s52, 7
    buffer_load_dwordx4 v8, s[36:39], s51 offen  lds
    s_add_u32 m0, s49, 1024
    s_lshr_b64 s[62:63], s[62:63], 4
    buffer_load_dwordx4 v9, s[36:39], s51 offen  lds
    s_add_u32 m0, s49, 8192
    s_add_u32 s56, s56, 1
    buffer_load_dwordx4 v14, s[36:39], s51 offen  lds
    s_add_u32 m0, s49, 9216
    s_cmp_eq_u32 s56, 4
    buffer_load_dwordx4 v15, s[36:39], s51 offen  lds
    s_cselect_b32 s56, 0, s56
    s_cselect_b32 s51, s55, 32768
    s_mov_b32 m0, s50
    s_add_u32 s49, s49, s51
    buffer_load_dwordx4 v10, s[32:35], s52 offen  lds
    s_add_u32 m0, s50, 1024
    s_nop 0
    buffer_load_dwordx4 v11, s[32:35], s52 offen  lds
    s_add_u32 m0, s50, 2048
    s_nop 0
    buffer_load_dwordx4 v12, s[32:35], s52 offen  lds
    s_add_u32 m0, s50, 3072
    s_add_u32 s50, s50, s51
    buffer_load_dwordx4 v13, s[32:35], s52 offen  lds
    s_branch L_hrest
L_crest:
    s_cmp_eq_u32 s97, 0
    s_cbranch_scc1 L_kv1
    s_add_u32 m0, s51, 123776
    s_nop 0
    buffer_load_dwordx4 v120, s[32:35], 0 offen offset:128  lds
    s_add_u32 m0, s51, 124800
    s_nop 0
    buffer_load_dwordx4 v120, s[36:39], 0 offen offset:128  lds
    s_add_u32 m0, s51, 122752
    s_mov_b32 exec_lo, 0
    s_mov_b32 exec_hi, 0xffffff00
    buffer_load_dwordx4 v121, s[32:35], 0 offen offset:128  lds
    s_mov_b64 exec, -1
    buffer_load_dwordx4 v[136:139], v123, s[40:43], s52 offen offset:512
    buffer_load_dwordx4 v[140:143], v123, s[40:43], s52 offen offset:528
L_kv1:
    s_mov_b32 s28, s26
    s_mov_b32 s29, s27
    s_mov_b32 s30, 268435456
    s_mov_b32 s31, 0x20000
    s_mov_b32 s45, 23068672
    s_load_dword s1, s[26:27], s45
    s_lshr_b32 s48, s44, 2
    s_lshl_b32 s48, s48, 5
    s_add_u32 s48, s48, s2
    s_lshl_b32 s48, s48, 2
    s_load_dword s0, s[20:21], s48
    s_mul_i32 s48, s93, 37
    s_lshr_b32 s48, s48, 8
    s_mul_i32 s49, s48, 7
    s_sub_u32 s49, s93, s49
    s_and_b32 s94, s92, 3
    s_lshl_b32 s94, s94, 2
    s_add_u32 s94, s94, s48
    s_lshr_b32 s95, s92, 2
    s_mul_i32 s95, s95, 7
    s_add_u32 s95, s95, s49
    s_and_b32 s98, s93, 3
    s_lshl_b32 s58, s92, 2
    s_add_u32 s98, s98, s58
    s_lshr_b32 s99, s93, 2
    s_sub_u32 s99, 7, s99
    v_lshrrev_b32 v124, 4, v2
    v_lshlrev_b32 v125, 8, v124
    v_lshl_add_u32 v125, v122, 3, v125
    s_add_u32 s51, s51, 98304
    v_add_u32 v125, s51, v125
    v_mul_u32_u24 v126, 576, v122
    v_lshl_add_u32 v126, v124, 2, v126
    s_lshl_b32 s51, s44, 4
    s_add_u32 s51, s51, 147456
    v_add_u32 v126, s51, v126
    s_lshr_b32 s48, s44, 2
    s_lshl_b32 s58, s48, 5
    s_add_u32 s58, s58, s2
    s_cmp_gt_u32 s48, s97
    s_cselect_b32 s69, 1, 0
    s_bfe_u32 s49, s44, 0x10001
    s_and_b32 s90, s44, 1
    s_cmp_eq_u32 s48, 0
    s_cselect_b32 s54, 98304, 0
    s_lshl_b32 s56, s90, 8
    v_and_b32 v20, 3, v2
    v_sub_u32 v20, 3, v20
    v_mul_u32_u24 v8, 4160, v20
    v_bfe_u32 v20, v2, 2, 2
    v_lshlrev_b32 v20, 3, v20
    v_sub_u32 v8, v8, v20
    v_lshrrev_b32 v21, 4, v2
    v_lshlrev_b32 v11, 3, v21
    v_lshlrev_b32 v22, 4, v21
    v_sub_u32 v8, v8, v22
    s_mul_i32 s50, s49, 16640
    s_add_u32 s50, s50, 520
    s_add_u32 s50, s50, s54
    s_sub_u32 s50, s50, s56
    v_add_u32 v8, s50, v8
    v_and_b32 v20, 15, v2
    v_lshlrev_b32 v9, 5, v20
    v_and_b32 v14, 1, v21
    v_lshl_add_u32 v14, v14, 9, v9
    v_lshrrev_b32 v21, 1, v21
    v_lshl_add_u32 v14, v21, 4, v14
    s_mul_i32 s50, s49, 4608
    s_add_u32 s50, s50, 33792
    s_add_u32 s50, s50, s54
    v_add_u32 v9, s50, v9
    v_add_u32 v11, v11, v9
    s_lshl_b32 s51, s90, 11
    v_add_u32 v11, s51, v11
    v_sub_u32 v9, v9, v22
    s_sub_u32 s50, 16, s56
    v_add_u32 v9, s50, v9
    s_lshl_b32 s89, s58, 1
    s_add_u32 s89, s89, s49
    s_lshl_b32 s89, s89, 12
    s_add_u32 s89, s89, s51
    s_add_u32 s89, s89, 18874368
    s_mov_b32 s59, 8256
    s_mov_b32 s47, 46080
    s_and_b32 s50, s44, 3
    s_lshl_b32 s64, s58, 5
    s_lshl_b32 s51, s50, 2
    s_add_u32 s64, s64, s51
    s_add_u32 s64, s64, 23199744
    s_lshl_b32 s51, s69, 31
    s_or_b32 s64, s64, s51
    s_xor_b32 s51, s50, 1
    s_cmp_eq_u32 s48, 0
    s_cselect_b32 s52, 4096, s59
    s_cselect_b32 s53, 140800, s47
    s_mul_i32 s50, s50, s52
    s_mul_i32 s51, s51, s52
    s_add_u32 s50, s50, s53
    s_add_u32 s51, s51, s53
    v_lshlrev_b32 v12, 4, v2
    v_add_u32 v13, s51, v12
    v_add_u32 v12, s50, v12
    s_lshl_b32 s50, s44, 2
    s_add_u32 s50, s50, 157184
    v_mov_b32 v10, s50
    v_and_b32 v30, 31, v2
    v_lshrrev_b32 v31, 5, v2
    s_lshl_b32 s60, s99, 3
    s_add_u32 s60, s60, s44
    s_lshl_b32 s47, s60, 9
    s_mul_i32 s50, s98, 18
    s_lshr_b32 s51, s50, 3
    s_lshl_b32 s61, s51, 15
    s_add_u32 s61, s61, s47
    s_add_u32 s61, s61, 0
    s_add_u32 s62, s61, 65536
    s_lshl_b32 s65, s98, 16
    s_add_u32 s65, s65, s47
    s_add_u32 s65, s65, 10485760
    s_lshl_b32 s66, s98, 13
    s_lshl_b32 s48, s60, 7
    s_add_u32 s66, s66, s48
    s_add_u32 s66, s66, 12582912
    s_lshl_b32 s67, s60, 5
    s_add_u32 s67, s67, s98
    s_lshl_b32 s67, s67, 4
    s_add_u32 s67, s67, 23592960
    s_lshr_b32 s63, s60, 1
    s_lshl_b32 s63, s63, 7
    s_add_u32 s63, s63, 23330816
    v_and_b32 v167, 2, v2
    v_add_u32 v167, s51, v167
    v_lshrrev_b32 v167, 2, v167
    v_lshlrev_b32 v167, 12, v167
    v_lshlrev_b32 v20, 4, v30
    v_lshl_add_u32 v166, v31, 15, v20
    s_mov_b32 s59, 0xf0
    s_bfe_u32 s52, s50, 0x20001
    s_lshl_b32 s53, 0x1ff, s52
    s_and_b32 s48, s53, 0x333
    s_lshl_b32 s48, s48, 2
    s_lshr_b32 s49, s53, 2
    s_and_b32 s49, s49, 0x333
    s_or_b32 s48, s48, s49
    s_xor_b32 s48, s48, s53
    s_bitcmp1_b32 s51, 0
    s_cselect_b32 s49, 0xf0f, s59
    s_and_b32 s48, s48, s49
    s_xor_b32 s53, s53, s48
    s_lshr_b32 s48, s53, 4
    s_and_b32 s49, s48, 0xf
    s_and_b32 s48, s48, 0xf0
    s_and_b32 s53, s53, 0xf
    s_or_b32 s53, s53, s48
    v_mov_b32 v165, s53
    s_and_b32 s68, s98, 1
    s_lshl_b32 s50, s44, 9
    s_add_u32 s53, s50, 46080
    v_mul_u32_u24 v160, 8256, v31
    v_add_u32 v160, v160, v20
    v_add_u32 v160, s53, v160
    v_add_u32 v161, s53, v20
    v_add_u32 v161, 16512, v161
    s_mov_b32 exec_lo, 0
    v_mov_b32 v165, s49
    v_mov_b32 v161, 157440
    s_mov_b32 exec_lo, -1
    v_and_b32 v23, 3, v2
    v_bfe_u32 v24, v2, 4, 1
    v_lshl_add_u32 v23, v24, 2, v23
    s_lshr_b32 s52, s52, 1
    s_add_u32 s53, s52, s68
    v_add_u32 v24, s53, v23
    v_mov_b32 v25, s52
    s_add_u32 s53, s52, 5
    v_cmp_eq_u32 vcc, s53, v24
    s_nop 1
    v_cndmask_b32 v24, v24, v25, vcc
    v_lshrrev_b32 v25, 1, v24
    v_mul_u32_u24 v162, 8256, v25
    v_add_u32 v25, s51, v25
    v_xor_b32 v25, v25, v24
    v_and_b32 v25, 1, v25
    v_lshl_add_u32 v162, v25, 3, v162
    v_bfe_u32 v25, v2, 2, 2
    v_lshl_add_u32 v25, v31, 2, v25
    v_lshl_add_u32 v162, v25, 4, v162
    s_add_u32 s53, s50, 70848
    v_add_u32 v162, s53, v162
    v_lshlrev_b32 v25, 6, v31
    v_add_u32 v25, 157568, v25
    v_cmp_lt_u32 vcc, 4, v23
    s_nop 1
    v_cndmask_b32 v162, v162, v25, vcc
    v_lshlrev_b32 v23, 2, v31
    v_sub_u32 v23, v30, v23
    v_mov_b32 v24, 0xffff
    v_cmp_le_i32 vcc, 0, v23
    v_cmp_le_i32 s[48:49], 1, v23
    s_nop 0
    v_cndmask_b32 v152, 0, v24, vcc
    v_cndmask_b32 v152, v152, -1, s[48:49]
    v_cmp_le_i32 vcc, 2, v23
    v_cmp_le_i32 s[48:49], 3, v23
    s_nop 0
    v_cndmask_b32 v153, 0, v24, vcc
    v_cndmask_b32 v153, v153, -1, s[48:49]
    v_cmp_le_i32 vcc, 8, v23
    v_cmp_le_i32 s[48:49], 9, v23
    s_nop 0
    v_cndmask_b32 v154, 0, v24, vcc
    v_cndmask_b32 v154, v154, -1, s[48:49]
    v_cmp_le_i32 vcc, 10, v23
    v_cmp_le_i32 s[48:49], 11, v23
    s_nop 0
    v_cndmask_b32 v155, 0, v24, vcc
    v_cndmask_b32 v155, v155, -1, s[48:49]
    v_cmp_le_i32 vcc, 16, v23
    v_cmp_le_i32 s[48:49], 17, v23
    s_nop 0
    v_cndmask_b32 v156, 0, v24, vcc
    v_cndmask_b32 v156, v156, -1, s[48:49]
    v_cmp_le_i32 vcc, 18, v23
    v_cmp_le_i32 s[48:49], 19, v23
    s_nop 0
    v_cndmask_b32 v157, 0, v24, vcc
    v_cndmask_b32 v157, v157, -1, s[48:49]
    v_cmp_le_i32 vcc, 24, v23
    v_cmp_le_i32 s[48:49], 25, v23
    s_nop 0
    v_cndmask_b32 v158, 0, v24, vcc
    v_cndmask_b32 v158, v158, -1, s[48:49]
    v_cmp_le_i32 vcc, 26, v23
    v_cmp_le_i32 s[48:49], 27, v23
    s_nop 0
    v_cndmask_b32 v159, 0, v24, vcc
    v_cndmask_b32 v159, v159, -1, s[48:49]
    s_lshl_b32 s48, s92, 2
    s_lshr_b32 s49, s93, 3
    s_add_u32 s48, s48, s49
    s_lshl_b32 s48, s48, 2
    s_and_b32 s49, s44, 3
    s_add_u32 s48, s48, s49
    s_lshr_b32 s47, s44, 2
    s_mov_b32 s91, s48
    s_mov_b32 s87, s47
    s_lshl_b32 s49, s48, 8
    s_lshl_b32 s50, s47, 20
    s_add_u32 s49, s49, s50
    s_add_u32 s70, s49, 10485760
    s_lshl_b32 s86, s48, 6
    s_lshl_b32 s50, s47, 17
    s_add_u32 s86, s86, s50
    s_add_u32 s86, s86, 12582912
    s_waitcnt lgkmcnt(0)
    s_mul_i32 s45, s1, 0x9e3779b1
    s_add_u32 s45, s45, 0x7f4a7c15
    s_cmp_eq_u32 s45, s1
    s_cselect_b32 s58, 1, 0
    s_xor_b32 s45, s45, s58
    s_lshl_b32 s50, s0, 16
    s_and_b32 s51, s0, 0xffff0000
    s_bitcmp0_b32 s44, 1
    s_cselect_b32 s88, s50, s51
    s_mov_b32 s54, s97
    s_waitcnt vmcnt(0)
L_b1:
    ds_read_b64 v[32:33], v125 offset:640
    ds_read_b64 v[34:35], v125 offset:768
    ds_read_b64 v[36:37], v125 offset:896
    ds_read_b64 v[38:39], v125 offset:1024
    ds_read_b64 v[40:41], v125 offset:1152
    ds_read_b64 v[42:43], v125 offset:2048
    ds_read_b64 v[44:45], v125 offset:2176
    v_lshlrev_b32 v68, 16, v128
    v_and_b32 v72, 0xffff0000, v128
    v_lshlrev_b32 v76, 16, v129
    v_and_b32 v80, 0xffff0000, v129
    v_lshlrev_b32 v69, 16, v130
    v_and_b32 v73, 0xffff0000, v130
    v_lshlrev_b32 v77, 16, v131
    v_and_b32 v81, 0xffff0000, v131
    v_lshlrev_b32 v70, 16, v132
    v_and_b32 v74, 0xffff0000, v132
    v_lshlrev_b32 v78, 16, v133
    v_and_b32 v82, 0xffff0000, v133
    v_lshlrev_b32 v71, 16, v134
    v_and_b32 v75, 0xffff0000, v134
    v_lshlrev_b32 v79, 16, v135
    v_and_b32 v83, 0xffff0000, v135
    s_waitcnt lgkmcnt(2)
    v_lshlrev_b32 v48, 16, v32
    v_and_b32 v49, 0xffff0000, v32
    v_lshlrev_b32 v50, 16, v33
    v_and_b32 v51, 0xffff0000, v33
    v_lshlrev_b32 v52, 16, v34
    v_and_b32 v53, 0xffff0000, v34
    v_lshlrev_b32 v54, 16, v35
    v_and_b32 v55, 0xffff0000, v35
    v_lshlrev_b32 v56, 16, v36
    v_and_b32 v57, 0xffff0000, v36
    v_lshlrev_b32 v58, 16, v37
    v_and_b32 v59, 0xffff0000, v37
    v_lshlrev_b32 v60, 16, v38
    v_and_b32 v61, 0xffff0000, v38
    v_lshlrev_b32 v62, 16, v39
    v_and_b32 v63, 0xffff0000, v39
    v_lshlrev_b32 v64, 16, v40
    v_and_b32 v65, 0xffff0000, v40
    v_lshlrev_b32 v66, 16, v41
    v_and_b32 v67, 0xffff0000, v41
    s_waitcnt lgkmcnt(0)
    v_pk_mul_f32 v[84:85], v[48:49], v[80:81]
    v_pk_fma_f32 v[84:85], v[52:53], v[76:77], v[84:85]
    v_pk_fma_f32 v[84:85], v[56:57], v[72:73], v[84:85]
    v_pk_fma_f32 v[84:85], v[60:61], v[68:69], v[84:85]
    v_lshlrev_b32 v92, 16, v42
    v_and_b32 v93, 0xffff0000, v42
    v_pk_mul_f32 v[84:85], v[84:85], v[92:93]
    v_pk_mul_f32 v[86:87], v[50:51], v[82:83]
    v_pk_fma_f32 v[86:87], v[54:55], v[78:79], v[86:87]
    v_pk_fma_f32 v[86:87], v[58:59], v[74:75], v[86:87]
    v_pk_fma_f32 v[86:87], v[62:63], v[70:71], v[86:87]
    v_lshlrev_b32 v94, 16, v43
    v_and_b32 v95, 0xffff0000, v43
    v_pk_mul_f32 v[86:87], v[86:87], v[94:95]
    v_pk_mul_f32 v[88:89], v[52:53], v[80:81]
    v_pk_fma_f32 v[88:89], v[56:57], v[76:77], v[88:89]
    v_pk_fma_f32 v[88:89], v[60:61], v[72:73], v[88:89]
    v_pk_fma_f32 v[88:89], v[64:65], v[68:69], v[88:89]
    v_lshlrev_b32 v92, 16, v44
    v_and_b32 v93, 0xffff0000, v44
    v_pk_mul_f32 v[88:89], v[88:89], v[92:93]
    v_pk_mul_f32 v[90:91], v[54:55], v[82:83]
    v_pk_fma_f32 v[90:91], v[58:59], v[78:79], v[90:91]
    v_pk_fma_f32 v[90:91], v[62:63], v[74:75], v[90:91]
    v_pk_fma_f32 v[90:91], v[66:67], v[70:71], v[90:91]
    v_lshlrev_b32 v94, 16, v45
    v_and_b32 v95, 0xffff0000, v45
    v_pk_mul_f32 v[90:91], v[90:91], v[94:95]
    v_cvt_pk_bf16_f32 v96, v84, v88
    ds_write_b32 v126, v96 offset:0
    v_cvt_pk_bf16_f32 v97, v85, v89
    ds_write_b32 v126, v97 offset:144
    v_cvt_pk_bf16_f32 v98, v86, v90
    ds_write_b32 v126, v98 offset:288
    v_cvt_pk_bf16_f32 v99, v87, v91
    ds_write_b32 v126, v99 offset:432
    s_cmp_eq_u32 s54, 0
    s_cbranch_scc1 L_b1done
    s_mov_b32 s54, 0
    v_mov_b32 v128, v136
    v_mov_b32 v129, v137
    v_mov_b32 v130, v138
    v_mov_b32 v131, v139
    v_mov_b32 v132, v140
    v_mov_b32 v133, v141
    v_mov_b32 v134, v142
    v_mov_b32 v135, v143
    v_add_u32 v125, 24576, v125
    v_subrev_u32 v126, 147456, v126
    s_branch L_b1
L_b1done:
    s_lshl_b32 s55, s2, 7
    s_add_u32 s55, s55, 23134208
    s_cmp_eq_u32 s97, 0
    s_cbranch_scc1 L_pres
    s_waitcnt lgkmcnt(0)
    s_barrier
L_pres:
    s_cmp_eq_u32 s97, 1
    s_cbranch_scc1 L_cidle
    s_lshr_b32 s53, s44, 2
    s_and_b32 s54, s44, 3
    v_and_b32 v20, 15, v2
    v_lshrrev_b32 v21, 4, v2
    s_lshl_b32 s46, s53, 13
    v_lshrrev_b32 v22, 1, v20
    v_xor_b32 v22, v22, v21
    v_lshlrev_b32 v22, 4, v22
    v_lshl_add_u32 v16, v20, 7, v22
    v_add_u32 v16, s46, v16
    v_xor_b32 v17, 64, v16
    v_bfe_u32 v22, v2, 2, 2
    v_lshl_add_u32 v22, v21, 3, v22
    v_lshlrev_b32 v18, 7, v22
    v_bfe_u32 v23, v2, 3, 1
    v_bfe_u32 v24, v2, 4, 1
    v_lshl_add_u32 v23, v24, 2, v23
    v_and_b32 v24, 3, v2
    v_xor_b32 v23, v23, v24
    s_and_b32 s46, s54, 1
    s_lshl_b32 s46, s46, 2
    v_xor_b32 v23, s46, v23
    v_lshl_add_u32 v18, v23, 4, v18
    v_and_b32 v24, 1, v2
    v_lshl_add_u32 v18, v24, 3, v18
    s_lshr_b32 s46, s54, 1
    s_lshl_b32 s46, s46, 13
    s_add_u32 s46, s46, 16384
    v_add_u32 v18, s46, v18
    v_xor_b32 v19, 8, v18
    v_mov_b32 v40, 0
    v_mov_b32 v41, 0
    v_mov_b32 v42, 0
    v_mov_b32 v43, 0
    v_mov_b32 v44, 0
    v_mov_b32 v45, 0
    v_mov_b32 v46, 0
    v_mov_b32 v47, 0
    v_mov_b32 v48, 0
    v_mov_b32 v49, 0
    v_mov_b32 v50, 0
    v_mov_b32 v51, 0
    v_mov_b32 v52, 0
    v_mov_b32 v53, 0
    v_mov_b32 v54, 0
    v_mov_b32 v55, 0
    v_mov_b32 v56, 0
    v_mov_b32 v57, 0
    v_mov_b32 v58, 0
    v_mov_b32 v59, 0
    v_mov_b32 v60, 0
    v_mov_b32 v61, 0
    v_mov_b32 v62, 0
    v_mov_b32 v63, 0
    v_mov_b32 v64, 0
    v_mov_b32 v65, 0
    v_mov_b32 v66, 0
    v_mov_b32 v67, 0
    v_mov_b32 v68, 0
    v_mov_b32 v69, 0
    v_mov_b32 v70, 0
    v_mov_b32 v71, 0
    s_mov_b32 s48, 0
    s_mov_b32 s50, 4294868992
    s_mov_b32 s49, 8
    s_cmp_eq_u32 s44, 7
    s_cselect_b32 s51, 6, 0
    s_waitcnt lgkmcnt(0)
    s_barrier
    ds_read_b128 v[72:75], v16
    ds_read_b64_tr_b16 v[88:89], v18 offset:0
    ds_read_b64_tr_b16 v[90:91], v18 offset:512
    ds_read_b64_tr_b16 v[92:93], v19 offset:0
    ds_read_b64_tr_b16 v[94:95], v19 offset:512
    ds_read_b128 v[76:79], v16 offset:2048
    ds_read_b128 v[80:83], v16 offset:4096
    ds_read_b128 v[84:87], v16 offset:6144
    s_branch L_a1loop
L_uf:
    v_mov_b32 v20, s55
    v_mov_b32 v21, s45
    s_mov_b64 exec, 1
    buffer_store_dword v21, v20, s[28:31], 0 offen sc1
    s_mov_b64 exec, -1
    s_branch L_ufb
    .p2align 6
L_a1loop:
    s_add_u32 s48, s48, 1
    s_cmp_eq_u32 s48, 4
    s_cselect_b32 s47, s50, 32768
    s_cselect_b32 s48, 0, s48
    s_waitcnt lgkmcnt(0)
    v_mfma_f32_16x16x32_bf16 v[40:43], v[88:91], v[72:75], v[40:43]
    ds_read_b128 v[96:99], v17
    ds_read_b64_tr_b16 v[112:113], v18 offset:4096
    v_mfma_f32_16x16x32_bf16 v[44:47], v[92:95], v[72:75], v[44:47]
    ds_read_b64_tr_b16 v[114:115], v18 offset:4608
    ds_read_b64_tr_b16 v[116:117], v19 offset:4096
    v_mfma_f32_16x16x32_bf16 v[48:51], v[88:91], v[76:79], v[48:51]
    ds_read_b64_tr_b16 v[118:119], v19 offset:4608
    ds_read_b128 v[100:103], v17 offset:2048
    v_mfma_f32_16x16x32_bf16 v[52:55], v[92:95], v[76:79], v[52:55]
    ds_read_b128 v[104:107], v17 offset:4096
    ds_read_b128 v[108:111], v17 offset:6144
    v_mfma_f32_16x16x32_bf16 v[56:59], v[88:91], v[80:83], v[56:59]
    v_add_u32 v16, s47, v16
    v_add_u32 v17, s47, v17
    v_mfma_f32_16x16x32_bf16 v[60:63], v[92:95], v[80:83], v[60:63]
    v_add_u32 v18, s47, v18
    v_add_u32 v19, s47, v19
    v_mfma_f32_16x16x32_bf16 v[64:67], v[88:91], v[84:87], v[64:67]
    v_mfma_f32_16x16x32_bf16 v[68:71], v[92:95], v[84:87], v[68:71]
    s_waitcnt lgkmcnt(0)
    s_cmp_eq_u32 s49, s51
    s_barrier
    s_cbranch_scc1 L_uf
L_ufb:
    v_mfma_f32_16x16x32_bf16 v[40:43], v[112:115], v[96:99], v[40:43]
    ds_read_b128 v[72:75], v16
    ds_read_b64_tr_b16 v[88:89], v18 offset:0
    v_mfma_f32_16x16x32_bf16 v[44:47], v[116:119], v[96:99], v[44:47]
    ds_read_b64_tr_b16 v[90:91], v18 offset:512
    ds_read_b64_tr_b16 v[92:93], v19 offset:0
    v_mfma_f32_16x16x32_bf16 v[48:51], v[112:115], v[100:103], v[48:51]
    ds_read_b64_tr_b16 v[94:95], v19 offset:512
    ds_read_b128 v[76:79], v16 offset:2048
    v_mfma_f32_16x16x32_bf16 v[52:55], v[116:119], v[100:103], v[52:55]
    ds_read_b128 v[80:83], v16 offset:4096
    ds_read_b128 v[84:87], v16 offset:6144
    v_mfma_f32_16x16x32_bf16 v[56:59], v[112:115], v[104:107], v[56:59]
    v_mfma_f32_16x16x32_bf16 v[60:63], v[116:119], v[104:107], v[60:63]
    v_mfma_f32_16x16x32_bf16 v[64:67], v[112:115], v[108:111], v[64:67]
    v_mfma_f32_16x16x32_bf16 v[68:71], v[116:119], v[108:111], v[68:71]
    s_sub_u32 s49, s49, 1
    s_cmp_lg_u32 s49, 0
    s_cbranch_scc1 L_a1loop
Wa0:
    s_cbranch_execz Wa1
    s_waitcnt lgkmcnt(0)
    v_mfma_f32_16x16x32_bf16 v[40:43], v[88:91], v[72:75], v[40:43]
    ds_read_b128 v[96:99], v17
    ds_read_b64_tr_b16 v[112:113], v18 offset:4096
    v_mfma_f32_16x16x32_bf16 v[44:47], v[92:95], v[72:75], v[44:47]
    ds_read_b64_tr_b16 v[114:115], v18 offset:4608
    ds_read_b64_tr_b16 v[116:117], v19 offset:4096
    v_mfma_f32_16x16x32_bf16 v[48:51], v[88:91], v[76:79], v[48:51]
    ds_read_b64_tr_b16 v[118:119], v19 offset:4608
    ds_read_b128 v[100:103], v17 offset:2048
    v_mfma_f32_16x16x32_bf16 v[52:55], v[92:95], v[76:79], v[52:55]
    ds_read_b128 v[104:107], v17 offset:4096
    ds_read_b128 v[108:111], v17 offset:6144
    v_mfma_f32_16x16x32_bf16 v[56:59], v[88:91], v[80:83], v[56:59]
    v_mfma_f32_16x16x32_bf16 v[60:63], v[92:95], v[80:83], v[60:63]
    v_mfma_f32_16x16x32_bf16 v[64:67], v[88:91], v[84:87], v[64:67]
    v_mfma_f32_16x16x32_bf16 v[68:71], v[92:95], v[84:87], v[68:71]
    s_lshl_b32 s47, s95, 2
    s_add_u32 s47, s47, s54
    s_cmp_lt_u32 s47, 18
    s_cselect_b32 s50, 0x3eae1a93, 1.0
    s_mov_b32 s51, s50
    s_lshl_b32 s49, s94, 1
    s_add_u32 s49, s49, s53
    s_lshl_b32 s48, s47, 17
    s_lshl_b32 s46, s49, 10
    s_add_u32 s48, s48, s46
    s_add_u32 s48, s48, 0
    s_lshl_b32 s3, s47, 5
    s_add_u32 s3, s3, s49
    s_lshl_b32 s3, s3, 7
    s_add_u32 s3, s3, 23330816
    v_lshrrev_b32 v20, 4, v2
    v_lshlrev_b32 v20, 15, v20
    v_and_b32 v21, 15, v2
    v_lshl_add_u32 v20, v21, 4, v20
    s_cmp_ge_u32 s47, 54
    s_cselect_b32 s46, 0x80000000, 0
    s_or_b32 s3, s3, s46
    v_or_b32 v20, s46, v20
    s_waitcnt lgkmcnt(0)
    v_mfma_f32_16x16x32_bf16 v[40:43], v[112:115], v[96:99], v[40:43]
    v_mfma_f32_16x16x32_bf16 v[44:47], v[116:119], v[96:99], v[44:47]
    v_mfma_f32_16x16x32_bf16 v[48:51], v[112:115], v[100:103], v[48:51]
    v_mfma_f32_16x16x32_bf16 v[52:55], v[116:119], v[100:103], v[52:55]
    v_mfma_f32_16x16x32_bf16 v[56:59], v[112:115], v[104:107], v[56:59]
    v_mfma_f32_16x16x32_bf16 v[60:63], v[116:119], v[104:107], v[60:63]
    v_mfma_f32_16x16x32_bf16 v[64:67], v[112:115], v[108:111], v[64:67]
    v_mfma_f32_16x16x32_bf16 v[68:71], v[116:119], v[108:111], v[68:71]
    s_cmp_lt_u32 s47, 18
    s_cbranch_scc1 L_epq
    v_cvt_pk_bf16_f32 v72, v40, v41
    v_cvt_pk_bf16_f32 v73, v42, v43
    v_cvt_pk_bf16_f32 v74, v44, v45
    v_cvt_pk_bf16_f32 v75, v46, v47
    buffer_store_dwordx4 v[72:75], v20, s[28:31], s48 offen offset:0 sc1
    v_cvt_pk_bf16_f32 v76, v48, v49
    v_cvt_pk_bf16_f32 v77, v50, v51
    v_cvt_pk_bf16_f32 v78, v52, v53
    v_cvt_pk_bf16_f32 v79, v54, v55
    buffer_store_dwordx4 v[76:79], v20, s[28:31], s48 offen offset:256 sc1
    v_cvt_pk_bf16_f32 v80, v56, v57
    v_cvt_pk_bf16_f32 v81, v58, v59
    v_cvt_pk_bf16_f32 v82, v60, v61
    v_cvt_pk_bf16_f32 v83, v62, v63
    buffer_store_dwordx4 v[80:83], v20, s[28:31], s48 offen offset:512 sc1
    v_cvt_pk_bf16_f32 v84, v64, v65
    v_cvt_pk_bf16_f32 v85, v66, v67
    v_cvt_pk_bf16_f32 v86, v68, v69
    v_cvt_pk_bf16_f32 v87, v70, v71
    buffer_store_dwordx4 v[84:87], v20, s[28:31], s48 offen offset:768 sc1
    s_branch L_cconv
L_epq:
    s_nop 0
    v_pk_mul_f32 v[40:41], v[40:41], s[50:51]
    v_pk_mul_f32 v[42:43], v[42:43], s[50:51]
    v_pk_mul_f32 v[44:45], v[44:45], s[50:51]
    v_pk_mul_f32 v[46:47], v[46:47], s[50:51]
    v_cvt_pk_bf16_f32 v72, v40, v41
    v_cvt_pk_bf16_f32 v73, v42, v43
    v_cvt_pk_bf16_f32 v74, v44, v45
Wa1:
    s_cbranch_execz Wa2
    v_cvt_pk_bf16_f32 v75, v46, v47
    buffer_store_dwordx4 v[72:75], v20, s[28:31], s48 offen offset:0 sc1
    v_pk_mul_f32 v[48:49], v[48:49], s[50:51]
    v_pk_mul_f32 v[50:51], v[50:51], s[50:51]
    v_pk_mul_f32 v[52:53], v[52:53], s[50:51]
    v_pk_mul_f32 v[54:55], v[54:55], s[50:51]
    v_cvt_pk_bf16_f32 v76, v48, v49
    v_cvt_pk_bf16_f32 v77, v50, v51
    v_cvt_pk_bf16_f32 v78, v52, v53
    v_cvt_pk_bf16_f32 v79, v54, v55
    buffer_store_dwordx4 v[76:79], v20, s[28:31], s48 offen offset:256 sc1
    v_pk_mul_f32 v[56:57], v[56:57], s[50:51]
    v_pk_mul_f32 v[58:59], v[58:59], s[50:51]
    v_pk_mul_f32 v[60:61], v[60:61], s[50:51]
    v_pk_mul_f32 v[62:63], v[62:63], s[50:51]
    v_cvt_pk_bf16_f32 v80, v56, v57
    v_cvt_pk_bf16_f32 v81, v58, v59
    v_cvt_pk_bf16_f32 v82, v60, v61
    v_cvt_pk_bf16_f32 v83, v62, v63
    buffer_store_dwordx4 v[80:83], v20, s[28:31], s48 offen offset:512 sc1
    v_pk_mul_f32 v[64:65], v[64:65], s[50:51]
    v_pk_mul_f32 v[66:67], v[66:67], s[50:51]
    v_pk_mul_f32 v[68:69], v[68:69], s[50:51]
    v_pk_mul_f32 v[70:71], v[70:71], s[50:51]
    v_cvt_pk_bf16_f32 v84, v64, v65
    v_cvt_pk_bf16_f32 v85, v66, v67
    v_cvt_pk_bf16_f32 v86, v68, v69
    v_cvt_pk_bf16_f32 v87, v70, v71
    buffer_store_dwordx4 v[84:87], v20, s[28:31], s48 offen offset:768 sc1
    s_branch L_cconv
L_cidle:
    s_mov_b32 s3, 0x80000000
    s_barrier
    s_mov_b32 s40, s8
    s_mov_b32 s41, s9
    s_mov_b32 s42, 663552
    s_mov_b32 s43, 0x20000
    s_sub_u32 s54, s2, 224
    v_lshlrev_b32 v20, 7, v0
    s_mul_i32 s50, s54, 20736
    v_add_u32 v20, s50, v20
    s_cmp_ge_u32 s44, 3
    s_cbranch_scc1 L_pfd
    buffer_load_dword v21, v20, s[40:43], 0 offen
    s_waitcnt vmcnt(0)
L_pfd:
    s_branch L_cconv
L_hrest:
    s_mov_b32 s28, s26
    s_mov_b32 s29, s27
    s_mov_b32 s30, 268435456
    s_mov_b32 s31, 0x20000
    s_mov_b32 s45, 23068672
    s_load_dword s1, s[26:27], s45
    s_and_b32 s52, s62, 15
    s_mul_i32 s51, s52, 221184
    s_mov_b32 m0, s49
    s_lshl_b32 s52, s52, 7
    buffer_load_dwordx4 v8, s[36:39], s51 offen  lds
    s_add_u32 m0, s49, 1024
    s_lshr_b64 s[62:63], s[62:63], 4
    buffer_load_dwordx4 v9, s[36:39], s51 offen  lds
    s_add_u32 m0, s49, 8192
    s_add_u32 s56, s56, 1
    buffer_load_dwordx4 v14, s[36:39], s51 offen  lds
    s_add_u32 m0, s49, 9216
    s_cmp_eq_u32 s56, 4
    buffer_load_dwordx4 v15, s[36:39], s51 offen  lds
    s_cselect_b32 s56, 0, s56
    s_cselect_b32 s51, s55, 32768
    s_mov_b32 m0, s50
    s_add_u32 s49, s49, s51
    buffer_load_dwordx4 v10, s[32:35], s52 offen  lds
    s_add_u32 m0, s50, 1024
    s_nop 0
    buffer_load_dwordx4 v11, s[32:35], s52 offen  lds
    s_add_u32 m0, s50, 2048
    s_nop 0
    buffer_load_dwordx4 v12, s[32:35], s52 offen  lds
    s_add_u32 m0, s50, 3072
    s_add_u32 s50, s50, s51
    buffer_load_dwordx4 v13, s[32:35], s52 offen  lds
    s_and_b32 s98, s93, 3
    s_lshl_b32 s58, s92, 2
    s_add_u32 s98, s98, s58
    s_lshr_b32 s99, s93, 2
    s_sub_u32 s99, 7, s99
    s_waitcnt lgkmcnt(0)
    s_mul_i32 s45, s1, 0x9e3779b1
    s_add_u32 s45, s45, 0x7f4a7c15
    s_cmp_eq_u32 s45, s1
    s_cselect_b32 s58, 1, 0
    s_xor_b32 s45, s45, s58
    s_mov_b64 exec, 0
    s_cmp_eq_u32 s57, 0
    s_cbranch_scc1 Wa0
    s_cmp_eq_u32 s57, 1
    s_cbranch_scc1 Wa4
    s_cmp_eq_u32 s57, 2
    s_cbranch_scc1 Wa8
    s_cmp_eq_u32 s57, 3
    s_cbranch_scc1 Wa12
L_wret0:
    s_mov_b64 exec, -1
    s_and_b32 s52, s62, 15
    s_mul_i32 s51, s52, 221184
    s_mov_b32 m0, s49
    s_lshl_b32 s52, s52, 7
    buffer_load_dwordx4 v8, s[36:39], s51 offen  lds
    s_add_u32 m0, s49, 1024
    s_lshr_b64 s[62:63], s[62:63], 4
    buffer_load_dwordx4 v9, s[36:39], s51 offen  lds
    s_add_u32 m0, s49, 8192
    s_add_u32 s56, s56, 1
    buffer_load_dwordx4 v14, s[36:39], s51 offen  lds
    s_add_u32 m0, s49, 9216
    s_cmp_eq_u32 s56, 4
    buffer_load_dwordx4 v15, s[36:39], s51 offen  lds
    s_cselect_b32 s56, 0, s56
    s_cselect_b32 s51, s55, 32768
    s_mov_b32 m0, s50
    s_add_u32 s49, s49, s51
    buffer_load_dwordx4 v10, s[32:35], s52 offen  lds
    s_add_u32 m0, s50, 1024
    s_nop 0
    buffer_load_dwordx4 v11, s[32:35], s52 offen  lds
    s_add_u32 m0, s50, 2048
    s_nop 0
    buffer_load_dwordx4 v12, s[32:35], s52 offen  lds
    s_add_u32 m0, s50, 3072
    s_add_u32 s50, s50, s51
    buffer_load_dwordx4 v13, s[32:35], s52 offen  lds
    s_waitcnt vmcnt(16)
    s_barrier
    v_lshrrev_b32 v21, 3, v20
    v_and_b32 v22, 7, v20
    v_mul_u32_u24 v23, 144, v21
    v_lshl_add_u32 v23, v22, 4, v23
    v_add_u32 v24, 147456, v23
    ds_read_b128 v[64:67], v24
    ds_read_b128 v[68:71], v24 offset:4608
    v_lshlrev_b32 v21, 12, v21
    v_lshl_add_u32 v21, v22, 4, v21
    s_lshr_b32 s53, s2, 5
    s_lshl_b32 s53, s53, 18
    s_and_b32 s54, s2, 31
    s_lshl_b32 s54, s54, 7
    s_add_u32 s53, s53, s54
    s_add_u32 s53, s53, 14680064
    s_waitcnt lgkmcnt(0)
    buffer_store_dwordx4 v[64:67], v21, s[28:31], s53 offen sc1
    s_add_u32 s53, s53, 131072
    buffer_store_dwordx4 v[68:71], v21, s[28:31], s53 offen sc1
    s_waitcnt vmcnt(10)
    s_barrier
    s_and_b32 s52, s62, 15
    s_mul_i32 s51, s52, 221184
    s_mov_b32 m0, s49
    s_lshl_b32 s52, s52, 7
    buffer_load_dwordx4 v8, s[36:39], s51 offen  lds
    s_add_u32 m0, s49, 1024
    s_lshr_b64 s[62:63], s[62:63], 4
    buffer_load_dwordx4 v9, s[36:39], s51 offen  lds
    s_add_u32 m0, s49, 8192
    s_add_u32 s56, s56, 1
    buffer_load_dwordx4 v14, s[36:39], s51 offen  lds
    s_add_u32 m0, s49, 9216
    s_cmp_eq_u32 s56, 4
    buffer_load_dwordx4 v15, s[36:39], s51 offen  lds
    s_cselect_b32 s56, 0, s56
    s_cselect_b32 s51, s55, 32768
    s_mov_b32 m0, s50
    s_add_u32 s49, s49, s51
    buffer_load_dwordx4 v10, s[32:35], s52 offen  lds
    s_add_u32 m0, s50, 1024
    s_nop 0
    buffer_load_dwordx4 v11, s[32:35], s52 offen  lds
    s_add_u32 m0, s50, 2048
    s_nop 0
    buffer_load_dwordx4 v12, s[32:35], s52 offen  lds
    s_add_u32 m0, s50, 3072
    s_add_u32 s50, s50, s51
    buffer_load_dwordx4 v13, s[32:35], s52 offen  lds
    v_and_b32 v88, 7, v2
    s_and_b32 s47, s2, 0xe0
    s_lshl_b32 s48, s57, 3
    s_add_u32 s47, s47, s48
    v_add_u32 v88, s47, v88
    v_bfe_u32 v89, v2, 3, 1
    v_and_b32 v89, s97, v89
    v_lshl_add_u32 v88, v89, 5, v88
    v_lshlrev_b32 v88, 7, v88
    v_add_u32 v88, 23134208, v88
    s_mov_b32 s40, s18
    s_mov_b32 s41, s19
    s_mov_b32 s42, 2359296
    s_mov_b32 s43, 0x20000
    v_lshlrev_b32 v21, 4, v20
    v_subrev_u32 v22, 8, v21
    s_lshl_b32 s53, s2, 13
    s_add_u32 s54, s53, 262144
    s_mov_b32 s48, 0xffff
    v_sub_u32 v23, 102384, v21
    v_lshrrev_b32 v24, 5, v20
    v_mul_u32_u24 v24, 4096, v24
    v_add_u32 v24, v24, v21
    v_add_u32 v24, 33280, v24
    v_subrev_u32 v25, 64, v20
    v_lshrrev_b32 v26, 1, v25
    v_mul_u32_u24 v26, 4160, v26
    v_and_b32 v27, 1, v20
    v_lshl_add_u32 v26, v27, 4, v26
    v_add_u32 v26, 4096, v26
    v_cmp_gt_u32 vcc, 16, v25
    s_nop 1
    v_cndmask_b32 v24, v24, v26, vcc
    v_mov_b32 v26, 33280
    v_cmp_gt_u32 vcc, 80, v20
    s_nop 1
    v_cndmask_b32 v24, v26, v24, vcc
    v_add_u32 v24, 98304, v24
    v_mov_b32 v80, 0
    v_mov_b32 v81, 0
    v_mov_b32 v82, 0
    v_mov_b32 v83, 0
    s_waitcnt vmcnt(10)
    s_barrier
    s_and_b32 s52, s62, 15
    s_mul_i32 s51, s52, 221184
    s_mov_b32 m0, s49
    s_lshl_b32 s52, s52, 7
    buffer_load_dwordx4 v8, s[36:39], s51 offen  lds
    s_add_u32 m0, s49, 1024
    s_lshr_b64 s[62:63], s[62:63], 4
    buffer_load_dwordx4 v9, s[36:39], s51 offen  lds
    s_add_u32 m0, s49, 8192
    s_add_u32 s56, s56, 1
    buffer_load_dwordx4 v14, s[36:39], s51 offen  lds
    s_add_u32 m0, s49, 9216
    s_cmp_eq_u32 s56, 4
    buffer_load_dwordx4 v15, s[36:39], s51 offen  lds
    s_cselect_b32 s56, 0, s56
    s_cselect_b32 s51, s55, 32768
    s_mov_b32 m0, s50
    s_add_u32 s49, s49, s51
    buffer_load_dwordx4 v10, s[32:35], s52 offen  lds
    s_add_u32 m0, s50, 1024
    s_nop 0
    buffer_load_dwordx4 v11, s[32:35], s52 offen  lds
    s_add_u32 m0, s50, 2048
    s_nop 0
    buffer_load_dwordx4 v12, s[32:35], s52 offen  lds
    s_add_u32 m0, s50, 3072
    s_add_u32 s50, s50, s51
    buffer_load_dwordx4 v13, s[32:35], s52 offen  lds
    s_waitcnt vmcnt(8)
    s_barrier
    s_and_b32 s52, s62, 15
    s_mul_i32 s51, s52, 221184
    s_mov_b32 m0, s49
    s_lshl_b32 s52, s52, 7
    buffer_load_dwordx4 v8, s[36:39], s51 offen  lds
    s_add_u32 m0, s49, 1024
    s_lshr_b64 s[62:63], s[62:63], 4
    buffer_load_dwordx4 v9, s[36:39], s51 offen  lds
    s_add_u32 m0, s49, 8192
    s_add_u32 s56, s56, 1
    buffer_load_dwordx4 v14, s[36:39], s51 offen  lds
    s_add_u32 m0, s49, 9216
    s_cmp_eq_u32 s56, 4
    buffer_load_dwordx4 v15, s[36:39], s51 offen  lds
    s_cselect_b32 s56, 0, s56
    s_cselect_b32 s51, s55, 32768
    s_mov_b32 m0, s50
    s_add_u32 s49, s49, s51
    buffer_load_dwordx4 v10, s[32:35], s52 offen  lds
    s_add_u32 m0, s50, 1024
    s_nop 0
    buffer_load_dwordx4 v11, s[32:35], s52 offen  lds
    s_add_u32 m0, s50, 2048
    s_nop 0
    buffer_load_dwordx4 v12, s[32:35], s52 offen  lds
    s_add_u32 m0, s50, 3072
    s_add_u32 s50, s50, s51
    buffer_load_dwordx4 v13, s[32:35], s52 offen  lds
    s_waitcnt vmcnt(8)
    s_barrier
    s_and_b32 s52, s62, 15
    s_mul_i32 s51, s52, 221184
    s_mov_b32 m0, s49
    s_lshl_b32 s52, s52, 7
    buffer_load_dwordx4 v8, s[36:39], s51 offen  lds
    s_add_u32 m0, s49, 1024
    s_lshr_b64 s[62:63], s[62:63], 4
    buffer_load_dwordx4 v9, s[36:39], s51 offen  lds
    s_add_u32 m0, s49, 8192
    s_add_u32 s56, s56, 1
    buffer_load_dwordx4 v14, s[36:39], s51 offen  lds
    s_add_u32 m0, s49, 9216
    s_cmp_eq_u32 s56, 4
    buffer_load_dwordx4 v15, s[36:39], s51 offen  lds
    s_cselect_b32 s56, 0, s56
    s_cselect_b32 s51, s55, 32768
    s_mov_b32 m0, s50
    s_add_u32 s49, s49, s51
    buffer_load_dwordx4 v10, s[32:35], s52 offen  lds
    s_add_u32 m0, s50, 1024
    s_nop 0
    buffer_load_dwordx4 v11, s[32:35], s52 offen  lds
    s_add_u32 m0, s50, 2048
    s_nop 0
    buffer_load_dwordx4 v12, s[32:35], s52 offen  lds
    s_add_u32 m0, s50, 3072
    s_add_u32 s50, s50, s51
    buffer_load_dwordx4 v13, s[32:35], s52 offen  lds
    s_and_b32 s52, s62, 15
    s_mul_i32 s51, s52, 221184
    s_mov_b32 m0, s49
    s_lshl_b32 s52, s52, 7
    buffer_load_dwordx4 v8, s[36:39], s51 offen  lds
    s_add_u32 m0, s49, 1024
    s_lshr_b64 s[62:63], s[62:63], 4
    buffer_load_dwordx4 v9, s[36:39], s51 offen  lds
    s_add_u32 m0, s49, 8192
    s_add_u32 s56, s56, 1
    buffer_load_dwordx4 v14, s[36:39], s51 offen  lds
    s_add_u32 m0, s49, 9216
    s_cmp_eq_u32 s56, 4
    buffer_load_dwordx4 v15, s[36:39], s51 offen  lds
    s_cselect_b32 s56, 0, s56
    s_cselect_b32 s51, s55, 32768
    s_mov_b32 m0, s50
    s_add_u32 s49, s49, s51
    buffer_load_dwordx4 v10, s[32:35], s52 offen  lds
    s_add_u32 m0, s50, 1024
    s_nop 0
    buffer_load_dwordx4 v11, s[32:35], s52 offen  lds
    s_add_u32 m0, s50, 2048
    s_nop 0
    buffer_load_dwordx4 v12, s[32:35], s52 offen  lds
    s_add_u32 m0, s50, 3072
    s_add_u32 s50, s50, s51
    buffer_load_dwordx4 v13, s[32:35], s52 offen  lds
    s_waitcnt vmcnt(16)
    s_barrier
    s_and_b32 s52, s62, 15
    s_mul_i32 s51, s52, 221184
    s_mov_b32 m0, s49
    s_lshl_b32 s52, s52, 7
    buffer_load_dwordx4 v8, s[36:39], s51 offen  lds
    s_add_u32 m0, s49, 1024
    s_lshr_b64 s[62:63], s[62:63], 4
    buffer_load_dwordx4 v9, s[36:39], s51 offen  lds
    s_add_u32 m0, s49, 8192
    s_add_u32 s56, s56, 1
    buffer_load_dwordx4 v14, s[36:39], s51 offen  lds
    s_add_u32 m0, s49, 9216
    s_cmp_eq_u32 s56, 4
    buffer_load_dwordx4 v15, s[36:39], s51 offen  lds
    s_cselect_b32 s56, 0, s56
    s_cselect_b32 s51, s55, 32768
    s_mov_b32 m0, s50
    s_add_u32 s49, s49, s51
    buffer_load_dwordx4 v10, s[32:35], s52 offen  lds
    s_add_u32 m0, s50, 1024
    s_nop 0
    buffer_load_dwordx4 v11, s[32:35], s52 offen  lds
    s_add_u32 m0, s50, 2048
    s_nop 0
    buffer_load_dwordx4 v12, s[32:35], s52 offen  lds
    s_add_u32 m0, s50, 3072
    s_add_u32 s50, s50, s51
    buffer_load_dwordx4 v13, s[32:35], s52 offen  lds
    buffer_load_dword v89, v88, s[28:31], 0 offen sc1
Wa2:
    s_cbranch_execz Wa3
    s_waitcnt vmcnt(17)
    s_barrier
    buffer_load_dwordx4 v[36:39], v21, s[40:43], s53 offen
    buffer_load_dwordx2 v[34:35], v22, s[40:43], s53 offen
    s_add_u32 s47, s53, 4096
    buffer_load_dwordx4 v[44:47], v21, s[40:43], s47 offen
    buffer_load_dwordx2 v[42:43], v22, s[40:43], s47 offen
Wa3:
    s_cbranch_execz L_wret0
    s_waitcnt vmcnt(13)
    s_barrier
    s_waitcnt vmcnt(4)
    v_cmp_ne_u32 vcc, s45, v89
    s_cmp_eq_u64 vcc, 0
    s_cselect_b32 s0, 0, 0x80000000
    v_or_b32 v21, s0, v21
    s_lshl_b32 s47, s57, 10
    s_add_u32 m0, s47, 132096
    s_add_u32 s47, s53, 14680064
    buffer_load_dwordx4 v21, s[28:31], s47 offen sc1 lds
    s_lshl_b32 s47, s57, 10
    s_add_u32 m0, s47, 136704
    s_add_u32 s47, s53, 14684160
    buffer_load_dwordx4 v21, s[28:31], s47 offen sc1 lds
    s_waitcnt vmcnt(7)
    s_barrier
    s_setprio 0
    s_waitcnt vmcnt(2)
    s_mov_b32 s48, 0xffff
    v_alignbit_b32 v64, v39, v39, 16
    v_alignbit_b32 v65, v38, v38, 16
    v_alignbit_b32 v66, v37, v37, 16
    v_alignbit_b32 v67, v36, v36, 16
    ds_write_b128 v23, v[64:67] offset:0
    v_bfi_b32 v68, s48, v39, v38
    v_bfi_b32 v69, s48, v38, v37
    v_bfi_b32 v70, s48, v37, v36
    v_bfi_b32 v71, s48, v36, v35
    ds_write_b128 v23, v[68:71] offset:4160
    v_alignbit_b32 v72, v38, v38, 16
    v_alignbit_b32 v73, v37, v37, 16
    v_alignbit_b32 v74, v36, v36, 16
    v_alignbit_b32 v75, v35, v35, 16
    ds_write_b128 v23, v[72:75] offset:8320
    v_bfi_b32 v76, s48, v38, v37
    v_bfi_b32 v77, s48, v37, v36
    v_bfi_b32 v78, s48, v36, v35
    v_bfi_b32 v79, s48, v35, v34
    ds_write_b128 v23, v[76:79] offset:12480
    ds_write_b128 v24, v[80:83]
    s_mov_b32 s48, 0xffff
    v_alignbit_b32 v64, v47, v47, 16
    v_alignbit_b32 v65, v46, v46, 16
    v_alignbit_b32 v66, v45, v45, 16
    v_alignbit_b32 v67, v44, v44, 16
    ds_write_b128 v23, v[64:67] offset:16640
    v_bfi_b32 v68, s48, v47, v46
    v_bfi_b32 v69, s48, v46, v45
    v_bfi_b32 v70, s48, v45, v44
    v_bfi_b32 v71, s48, v44, v43
    ds_write_b128 v23, v[68:71] offset:20800
    v_alignbit_b32 v72, v46, v46, 16
    v_alignbit_b32 v73, v45, v45, 16
    v_alignbit_b32 v74, v44, v44, 16
    v_alignbit_b32 v75, v43, v43, 16
    ds_write_b128 v23, v[72:75] offset:24960
    v_bfi_b32 v76, s48, v46, v45
    v_bfi_b32 v77, s48, v45, v44
    v_bfi_b32 v78, s48, v44, v43
    v_bfi_b32 v79, s48, v43, v42
    ds_write_b128 v23, v[76:79] offset:29120
    s_cmp_eq_u32 s0, 0
    s_cbranch_scc1 L_hx1
    v_lshlrev_b32 v21, 4, v20
    s_mov_b32 s59, 262144
L_hu1p:
    buffer_load_dword v89, v88, s[28:31], 0 offen sc1
    s_waitcnt vmcnt(0)
    v_cmp_ne_u32 vcc, s45, v89
    s_nop 0
    s_cbranch_vccz L_hu1d
    s_sleep 4
    s_sub_u32 s59, s59, 1
    s_cmp_lg_u32 s59, 0
    s_cbranch_scc1 L_hu1p
L_hu1d:
    s_lshl_b32 s47, s57, 10
    s_add_u32 m0, s47, 132096
    s_add_u32 s47, s53, 14680064
    buffer_load_dwordx4 v21, s[28:31], s47 offen sc1 lds
    s_lshl_b32 s47, s57, 10
Wa4:
    s_cbranch_execz Wa5
    s_add_u32 m0, s47, 136704
    s_add_u32 s47, s53, 14684160
    buffer_load_dwordx4 v21, s[28:31], s47 offen sc1 lds
    s_branch L_hx1
L_hidle:
    s_waitcnt lgkmcnt(0)
    s_barrier
    s_mov_b32 s28, s26
    s_mov_b32 s29, s27
    s_mov_b32 s30, 268435456
    s_mov_b32 s31, 0x20000
    s_mov_b32 s45, 23068672
    s_load_dword s1, s[26:27], s45
    s_and_b32 s98, s93, 3
    s_lshl_b32 s58, s92, 2
    s_add_u32 s98, s98, s58
    s_lshr_b32 s99, s93, 2
    s_sub_u32 s99, 7, s99
    v_and_b32 v88, 7, v2
    s_and_b32 s47, s2, 0xe0
    s_lshl_b32 s48, s57, 3
    s_add_u32 s47, s47, s48
    v_add_u32 v88, s47, v88
    v_bfe_u32 v89, v2, 3, 1
    v_and_b32 v89, s97, v89
    v_lshl_add_u32 v88, v89, 5, v88
    v_lshlrev_b32 v88, 7, v88
    v_add_u32 v88, 23134208, v88
    s_waitcnt lgkmcnt(0)
    s_mul_i32 s45, s1, 0x9e3779b1
    s_add_u32 s45, s45, 0x7f4a7c15
    s_cmp_eq_u32 s45, s1
    s_cselect_b32 s58, 1, 0
    s_xor_b32 s45, s45, s58
    s_barrier
    v_lshrrev_b32 v21, 3, v20
    v_and_b32 v22, 7, v20
    v_mul_u32_u24 v23, 144, v21
    v_lshl_add_u32 v23, v22, 4, v23
    v_add_u32 v24, 147456, v23
    ds_read_b128 v[64:67], v24
    ds_read_b128 v[68:71], v24 offset:4608
    ds_read_b128 v[72:75], v23
    ds_read_b128 v[76:79], v23 offset:4608
    v_lshlrev_b32 v21, 12, v21
    v_lshl_add_u32 v21, v22, 4, v21
    s_lshr_b32 s53, s2, 5
    s_lshl_b32 s53, s53, 18
    s_and_b32 s54, s2, 31
    s_lshl_b32 s54, s54, 7
    s_add_u32 s53, s53, s54
    s_add_u32 s53, s53, 14680064
    s_waitcnt lgkmcnt(0)
    buffer_store_dwordx4 v[64:67], v21, s[28:31], s53 offen sc1
    s_add_u32 s53, s53, 131072
    buffer_store_dwordx4 v[68:71], v21, s[28:31], s53 offen sc1
    s_add_u32 s53, s53, 131072
    buffer_store_dwordx4 v[72:75], v21, s[28:31], s53 offen sc1
    s_add_u32 s53, s53, 131072
    buffer_store_dwordx4 v[76:79], v21, s[28:31], s53 offen sc1
    s_mov_b32 s40, s18
    s_mov_b32 s41, s19
    s_mov_b32 s42, 2359296
    s_mov_b32 s43, 0x20000
    v_lshlrev_b32 v21, 4, v20
    v_subrev_u32 v22, 8, v21
    s_lshl_b32 s53, s2, 13
    s_add_u32 s54, s53, 262144
    s_mov_b32 s48, 0xffff
    v_sub_u32 v23, 102384, v21
    v_lshrrev_b32 v24, 5, v20
    v_mul_u32_u24 v24, 4096, v24
    v_add_u32 v24, v24, v21
    v_add_u32 v24, 33280, v24
    v_subrev_u32 v25, 64, v20
    v_lshrrev_b32 v26, 1, v25
    v_mul_u32_u24 v26, 4160, v26
    v_and_b32 v27, 1, v20
    v_lshl_add_u32 v26, v27, 4, v26
    v_add_u32 v26, 4096, v26
    v_cmp_gt_u32 vcc, 16, v25
    s_nop 1
    v_cndmask_b32 v24, v24, v26, vcc
    v_mov_b32 v26, 33280
    v_cmp_gt_u32 vcc, 80, v20
    s_nop 1
    v_cndmask_b32 v24, v26, v24, vcc
    v_add_u32 v24, 98304, v24
    v_mov_b32 v80, 0
    v_mov_b32 v81, 0
    v_mov_b32 v82, 0
    v_mov_b32 v83, 0
    buffer_load_dwordx4 v[36:39], v21, s[40:43], s53 offen
    buffer_load_dwordx2 v[34:35], v22, s[40:43], s53 offen
    s_add_u32 s47, s53, 4096
    buffer_load_dwordx4 v[44:47], v21, s[40:43], s47 offen
    buffer_load_dwordx2 v[42:43], v22, s[40:43], s47 offen
    buffer_load_dwordx4 v[52:55], v21, s[40:43], s54 offen
    buffer_load_dwordx2 v[50:51], v22, s[40:43], s54 offen
    s_add_u32 s47, s54, 4096
    buffer_load_dwordx4 v[60:63], v21, s[40:43], s47 offen
    buffer_load_dwordx2 v[58:59], v22, s[40:43], s47 offen
    s_waitcnt vmcnt(8)
    s_barrier
    s_lshl_b32 s47, s57, 5
    s_add_u32 s47, s47, s2
    s_lshl_b32 s47, s47, 7
    s_add_u32 s47, s47, 23134208
    s_cmp_le_u32 s57, 1
    s_cselect_b32 s47, s47, 0x80000000
    v_mov_b32 v90, s47
    v_mov_b32 v91, s45
    s_mov_b64 exec, 1
    buffer_store_dword v91, v90, s[28:31], 0 offen sc1
    s_mov_b64 exec, -1
    s_waitcnt vmcnt(1)
    s_mov_b32 s48, 0xffff
    v_alignbit_b32 v64, v39, v39, 16
    v_alignbit_b32 v65, v38, v38, 16
    v_alignbit_b32 v66, v37, v37, 16
    v_alignbit_b32 v67, v36, v36, 16
    ds_write_b128 v23, v[64:67] offset:0
    v_bfi_b32 v68, s48, v39, v38
    v_bfi_b32 v69, s48, v38, v37
    v_bfi_b32 v70, s48, v37, v36
    v_bfi_b32 v71, s48, v36, v35
    ds_write_b128 v23, v[68:71] offset:4160
    v_alignbit_b32 v72, v38, v38, 16
    v_alignbit_b32 v73, v37, v37, 16
    v_alignbit_b32 v74, v36, v36, 16
    v_alignbit_b32 v75, v35, v35, 16
    ds_write_b128 v23, v[72:75] offset:8320
    v_bfi_b32 v76, s48, v38, v37
    v_bfi_b32 v77, s48, v37, v36
    v_bfi_b32 v78, s48, v36, v35
    v_bfi_b32 v79, s48, v35, v34
    ds_write_b128 v23, v[76:79] offset:12480
    ds_write_b128 v24, v[80:83]
    s_mov_b32 s48, 0xffff
    v_alignbit_b32 v64, v47, v47, 16
    v_alignbit_b32 v65, v46, v46, 16
    v_alignbit_b32 v66, v45, v45, 16
    v_alignbit_b32 v67, v44, v44, 16
    ds_write_b128 v23, v[64:67] offset:16640
    v_bfi_b32 v68, s48, v47, v46
    v_bfi_b32 v69, s48, v46, v45
    v_bfi_b32 v70, s48, v45, v44
    v_bfi_b32 v71, s48, v44, v43
    ds_write_b128 v23, v[68:71] offset:20800
    v_alignbit_b32 v72, v46, v46, 16
    v_alignbit_b32 v73, v45, v45, 16
    v_alignbit_b32 v74, v44, v44, 16
    v_alignbit_b32 v75, v43, v43, 16
    ds_write_b128 v23, v[72:75] offset:24960
    v_bfi_b32 v76, s48, v46, v45
    v_bfi_b32 v77, s48, v45, v44
    v_bfi_b32 v78, s48, v44, v43
    v_bfi_b32 v79, s48, v43, v42
    ds_write_b128 v23, v[76:79] offset:29120
    v_subrev_u32 v23, 98304, v23
    v_subrev_u32 v24, 98304, v24
    s_mov_b32 s48, 0xffff
    v_alignbit_b32 v64, v55, v55, 16
    v_alignbit_b32 v65, v54, v54, 16
    v_alignbit_b32 v66, v53, v53, 16
    v_alignbit_b32 v67, v52, v52, 16
    ds_write_b128 v23, v[64:67] offset:0
    v_bfi_b32 v68, s48, v55, v54
    v_bfi_b32 v69, s48, v54, v53
    v_bfi_b32 v70, s48, v53, v52
    v_bfi_b32 v71, s48, v52, v51
    ds_write_b128 v23, v[68:71] offset:4160
    v_alignbit_b32 v72, v54, v54, 16
    v_alignbit_b32 v73, v53, v53, 16
    v_alignbit_b32 v74, v52, v52, 16
    v_alignbit_b32 v75, v51, v51, 16
    ds_write_b128 v23, v[72:75] offset:8320
    v_bfi_b32 v76, s48, v54, v53
    v_bfi_b32 v77, s48, v53, v52
    v_bfi_b32 v78, s48, v52, v51
    v_bfi_b32 v79, s48, v51, v50
    ds_write_b128 v23, v[76:79] offset:12480
    ds_write_b128 v24, v[80:83]
    s_mov_b32 s48, 0xffff
    v_alignbit_b32 v64, v63, v63, 16
    v_alignbit_b32 v65, v62, v62, 16
    v_alignbit_b32 v66, v61, v61, 16
    v_alignbit_b32 v67, v60, v60, 16
    ds_write_b128 v23, v[64:67] offset:16640
    v_bfi_b32 v68, s48, v63, v62
    v_bfi_b32 v69, s48, v62, v61
    v_bfi_b32 v70, s48, v61, v60
    v_bfi_b32 v71, s48, v60, v59
    ds_write_b128 v23, v[68:71] offset:20800
    v_alignbit_b32 v72, v62, v62, 16
    v_alignbit_b32 v73, v61, v61, 16
    v_alignbit_b32 v74, v60, v60, 16
    v_alignbit_b32 v75, v59, v59, 16
    ds_write_b128 v23, v[72:75] offset:24960
    v_bfi_b32 v76, s48, v62, v61
    v_bfi_b32 v77, s48, v61, v60
    v_bfi_b32 v78, s48, v60, v59
    v_bfi_b32 v79, s48, v59, v58
    ds_write_b128 v23, v[76:79] offset:29120
    s_mov_b32 s59, 262144
L_hu2p:
    buffer_load_dword v89, v88, s[28:31], 0 offen sc1
    s_waitcnt vmcnt(0)
    v_cmp_ne_u32 vcc, s45, v89
    s_nop 0
    s_cbranch_vccz L_hu2d
    s_sleep 8
    s_sub_u32 s59, s59, 1
    s_cmp_lg_u32 s59, 0
    s_cbranch_scc1 L_hu2p
L_hu2d:
    s_lshl_b32 s47, s57, 10
    s_add_u32 m0, s47, 132096
    s_add_u32 s47, s53, 14680064
    buffer_load_dwordx4 v21, s[28:31], s47 offen sc1 lds
    s_lshl_b32 s47, s57, 10
    s_add_u32 m0, s47, 136704
    s_add_u32 s47, s53, 14684160
    buffer_load_dwordx4 v21, s[28:31], s47 offen sc1 lds
    s_lshl_b32 s47, s57, 10
    s_add_u32 m0, s47, 33792
    s_add_u32 s47, s54, 14680064
    buffer_load_dwordx4 v21, s[28:31], s47 offen sc1 lds
    s_lshl_b32 s47, s57, 10
    s_add_u32 m0, s47, 38400
    s_add_u32 s47, s54, 14684160
    buffer_load_dwordx4 v21, s[28:31], s47 offen sc1 lds
L_hx1:
Wa5:
    s_cbranch_execz Wa6
    s_waitcnt vmcnt(0) lgkmcnt(0)
    s_barrier
    s_setprio 3
    s_mul_i32 s46, s98, 18
    s_lshr_b32 s46, s46, 3
    s_lshl_b32 s50, s46, 15
    s_lshl_b32 s47, s99, 12
    s_add_u32 s50, s50, s47
    s_lshl_b32 s51, s57, 11
    s_add_u32 s50, s50, s51
    s_add_u32 s50, s50, 2355200
    v_lshlrev_b32 v14, 4, v2
    s_lshl_b32 s49, s99, 1
    s_add_u32 s49, s49, s57
    s_cmp_lt_u32 s49, 2
    s_cbranch_scc1 L_staged
    v_bfe_u32 v8, v2, 2, 1
    v_add_u32 v8, 1, v8
    v_and_b32 v10, 1, v2
    s_lshl_b32 s48, s49, 1
    s_sub_u32 s48, s48, 4
    v_add_u32 v10, s48, v10
    s_lshl_b32 s48, s99, 2
    s_add_u32 s48, s48, s57
    s_mov_b64 exec, 0xff00
    v_mov_b32 v8, 0
    v_mov_b32 v10, s48
    s_mov_b64 exec, -1
    v_and_b32 v9, 2, v2
    v_add_u32 v9, s46, v9
    v_lshrrev_b32 v9, 2, v9
    v_mad_u32_u24 v9, v8, 18, v9
    v_lshl_add_u32 v9, v9, 5, v10
    v_lshlrev_b32 v9, 7, v9
    s_lshl_b32 s53, s46, 15
    s_lshl_b32 s48, s48, 10
    s_add_u32 s53, s53, s48
    s_add_u32 s53, s53, 0
    s_mov_b32 s48, 23330816
    s_cmp_eq_u32 s97, 0
    s_cselect_b32 s47, 208, 0
    s_cselect_b32 s52, 7, 3
    v_and_b32 v11, s52, v2
    v_lshlrev_b32 v11, 2, v11
    v_add_u32 v11, s47, v11
    v_add_u32 v11, 157184, v11
    s_mov_b32 s59, 262144
L_drnp:
    ds_read_b32 v13, v11 offset:0
    s_waitcnt lgkmcnt(0)
    v_cmp_eq_u32 vcc, 0, v13
    s_nop 0
    s_cbranch_vccz L_drnd
    s_sleep 1
    s_sub_u32 s59, s59, 1
    s_cmp_lg_u32 s59, 0
    s_cbranch_scc1 L_drnp
L_drnd:
    s_movk_i32 s47, 0xff
    s_cmp_eq_u32 s97, 0
    s_cselect_b32 exec_lo, 255, s47
    s_mov_b32 exec_hi, 0
    s_mov_b32 s59, 262144
L_hgp:
    v_mov_b32 v100, 0
    buffer_atomic_or v100, v9, s[28:31], s48 offen sc0 sc1
    s_waitcnt vmcnt(0)
    v_cmp_ne_u32 vcc, s45, v100
    s_nop 0
    s_cbranch_vccz L_hgd
    s_mov_b64 exec, vcc
    s_cbranch_vccz L_hgd
    s_sleep 4
    s_sub_u32 s59, s59, 1
    s_cmp_lg_u32 s59, 0
    s_cbranch_scc1 L_hgp
L_hgd:
    s_mov_b64 exec, -1
Wa6:
    s_cbranch_execz Wa7
    s_add_u32 m0, s51, 46080
    s_add_u32 s48, s50, 0
    buffer_load_dwordx4 v14, s[28:31], s48 offen sc1 lds
    buffer_load_dwordx4 v14, s[28:31], s48 offen offset:1024 sc1 lds
    s_add_u32 m0, s51, 54336
    s_add_u32 s48, s50, 32768
    buffer_load_dwordx4 v14, s[28:31], s48 offen sc1 lds
    buffer_load_dwordx4 v14, s[28:31], s48 offen offset:1024 sc1 lds
    s_add_u32 m0, s51, 62592
    s_add_u32 s48, s50, 65536
    buffer_load_dwordx4 v14, s[28:31], s48 offen sc1 lds
    buffer_load_dwordx4 v14, s[28:31], s48 offen offset:1024 sc1 lds
    s_add_u32 m0, s51, 70848
    s_add_u32 s48, s50, 2359296
    buffer_load_dwordx4 v14, s[28:31], s48 offen sc1 lds
    buffer_load_dwordx4 v14, s[28:31], s48 offen offset:1024 sc1 lds
    s_add_u32 m0, s51, 79104
    s_add_u32 s48, s50, 2392064
    buffer_load_dwordx4 v14, s[28:31], s48 offen sc1 lds
    buffer_load_dwordx4 v14, s[28:31], s48 offen offset:1024 sc1 lds
    s_add_u32 m0, s51, 87360
    s_add_u32 s48, s50, 2424832
    buffer_load_dwordx4 v14, s[28:31], s48 offen sc1 lds
    buffer_load_dwordx4 v14, s[28:31], s48 offen offset:1024 sc1 lds
L_staged:
    s_lshl_b32 s47, s57, 2
    s_add_u32 s47, s47, 157184
    v_mov_b32 v12, s47
    v_mov_b32 v13, 1
    ds_write_b32 v12, v13 offset:192
    s_lshl_b32 s94, s92, 2
    s_lshr_b32 s95, s93, 3
    s_add_u32 s94, s94, s95
    s_and_b32 s95, s93, 7
    s_mov_b32 s36, s10
    s_mov_b32 s37, s11
    s_mov_b32 s38, 2359296
    s_mov_b32 s39, 0x20000
    s_mov_b32 s32, s8
    s_mov_b32 s33, s9
    s_mov_b32 s34, 663552
    s_mov_b32 s35, 0x20000
    v_and_b32 v16, 15, v2
    v_lshrrev_b32 v17, 4, v2
    s_lshl_b32 s46, s94, 6
    s_and_b32 s47, s57, 1
    s_lshl_b32 s47, s47, 5
    s_add_u32 s46, s46, s47
    v_add_u32 v18, s46, v16
    v_mul_u32_u24 v18, 1152, v18
    s_mul_i32 s50, s95, 144
    v_lshl_add_u32 v19, v17, 4, s50
    v_lshl_add_u32 v20, v18, 1, v19
    v_add_u32 v18, v18, v19
    v_mul_u32_u24 v21, 52, v2
    v_lshrrev_b32 v21, 9, v21
    v_mul_u32_u24 v22, 10, v21
    v_sub_u32 v22, v2, v22
    v_mul_u32_u24 v21, 1152, v21
    v_lshl_add_u32 v21, v22, 4, v21
    s_mul_i32 s51, s57, 165888
    s_add_u32 s51, s51, s50
    v_add_u32 v21, s51, v21
    s_lshr_b32 s47, s57, 1
    s_and_b32 s48, s57, 1
    s_mul_i32 s52, s47, 95616
    s_mul_i32 s53, s48, 23040
    s_add_u32 s52, s52, s53
    s_add_u32 s52, s52, 0
    s_and_b32 s54, s94, 3
    s_mul_i32 s54, s54, 6
    v_lshlrev_b32 v23, 5, v2
    s_mul_i32 s46, s95, 1152
    s_add_u32 s46, s46, 23199744
    v_min_u32 v8, 11, v2
    v_lshlrev_b32 v8, 2, v8
    v_add_u32 v8, 157344, v8
    s_waitcnt vmcnt(0)
    ds_write_b32 v12, v13 offset:144
    s_mov_b32 s59, 262144
L_rdyp:
    ds_read_b32 v9, v8 offset:0
Wa7:
    s_cbranch_execz L_wret0
    s_waitcnt lgkmcnt(0)
    v_cmp_eq_u32 vcc, 0, v9
    s_nop 0
    s_cbranch_vccz L_rdyd
    s_sleep 1
    s_sub_u32 s59, s59, 1
    s_cmp_lg_u32 s59, 0
    s_cbranch_scc1 L_rdyp
L_rdyd:
    s_cmp_lt_u32 s57, 2
    s_cbranch_scc1 L_noq
    s_mov_b32 s55, 18432
    buffer_load_dwordx4 v[32:35], v18, s[36:39], 0 offen
    buffer_load_dwordx4 v[36:39], v18, s[36:39], 0 offen offset:64
    s_mov_b64 exec, 0xffff
    buffer_load_dwordx4 v[40:43], v18, s[36:39], 0 offen offset:128
    s_mov_b64 exec, -1
    buffer_load_dwordx4 v[44:47], v18, s[36:39], s55 offen
    buffer_load_dwordx4 v[48:51], v18, s[36:39], s55 offen offset:64
    s_mov_b64 exec, 0xffff
    buffer_load_dwordx4 v[52:55], v18, s[36:39], s55 offen offset:128
    s_mov_b64 exec, -1
L_noq:
    s_mov_b32 s53, 24
    s_mov_b32 exec_lo, 0xdff7fdff
    s_mov_b32 exec_hi, 0x7fdff7f
L_wol1:
    s_mul_i32 s55, s54, 960
    s_add_u32 m0, s55, s52
    s_mul_i32 s55, s54, 6912
    s_add_u32 s54, s54, 1
    buffer_load_dwordx4 v21, s[32:35], s55 offen lds
    s_waitcnt vmcnt(10)
    s_cmp_eq_u32 s54, 24
    s_cselect_b32 s54, 0, s54
    s_sub_u32 s53, s53, 1
    s_cmp_lg_u32 s53, 0
    s_cbranch_scc1 L_wol1
    s_mov_b64 exec, -1
    s_cmp_lt_u32 s57, 2
    s_cbranch_scc1 L_h01
    v_mov_b32 v80, 157216
    v_lshrrev_b32 v21, 2, v2
    v_lshlrev_b32 v21, 12, v21
    v_and_b32 v22, 3, v2
    v_lshl_add_u32 v21, v22, 4, v21
    s_mul_i32 s50, s95, 294912
    s_lshl_b32 s47, s94, 7
    s_add_u32 s50, s50, s47
    s_and_b32 s48, s57, 1
    s_lshl_b32 s47, s48, 6
    s_add_u32 s50, s50, s47
    s_add_u32 s50, s50, 18874368
    s_mul_i32 s48, s48, 6144
    s_add_u32 s48, s48, 141696
    v_bfe_u32 v19, v2, 2, 2
    v_lshl_add_u32 v19, v17, 3, v19
    v_lshlrev_b32 v19, 6, v19
    v_lshl_add_u32 v19, v22, 3, v19
    v_add_u32 v19, s48, v19
    s_waitcnt vmcnt(0)
    ds_write_b32 v12, v13 offset:36
    s_mov_b32 s59, 262144
L_yxp:
    ds_read_b32 v81, v80 offset:0
    s_waitcnt lgkmcnt(0)
    v_cmp_eq_u32 vcc, 0, v81
    s_nop 0
    s_cbranch_vccz L_yxd
    s_sleep 1
    s_sub_u32 s59, s59, 1
    s_cmp_lg_u32 s59, 0
    s_cbranch_scc1 L_yxp
L_yxd:
    s_add_u32 m0, s48, 0
    s_nop 0
    buffer_load_dwordx4 v21, s[28:31], s50 offen sc1 lds
    s_add_u32 s50, s50, 65536
    s_add_u32 m0, s48, 1024
    s_nop 0
    buffer_load_dwordx4 v21, s[28:31], s50 offen sc1 lds
    s_add_u32 s50, s50, 65536
    s_add_u32 m0, s48, 2048
    s_nop 0
    buffer_load_dwordx4 v21, s[28:31], s50 offen sc1 lds
    s_add_u32 s50, s50, 65536
    s_add_u32 m0, s48, 3072
    s_nop 0
    buffer_load_dwordx4 v21, s[28:31], s50 offen sc1 lds
    s_add_u32 s50, s50, 65536
    s_add_u32 m0, s48, 4096
    s_mov_b32 exec_hi, 0
    buffer_load_dwordx4 v21, s[28:31], s50 offen sc1 lds
    s_mov_b64 exec, -1
    s_mov_b32 s49, 1152
    s_setprio 3
    s_mov_b32 s36, s22
    s_mov_b32 s37, s23
    s_mov_b32 s38, 4718592
    s_mov_b32 s39, 0x20000
    s_waitcnt vmcnt(0)
L_b3l:
    ds_read_b64_tr_b16 v[56:57], v19 offset:0
    ds_read_b64_tr_b16 v[58:59], v19 offset:256
    ds_read_b64_tr_b16 v[60:61], v19 offset:2048
    ds_read_b64_tr_b16 v[62:63], v19 offset:2304
    ds_read_b64_tr_b16 v[64:65], v19 offset:4096
    ds_read_b64_tr_b16 v[66:67], v19 offset:4352
    s_waitcnt lgkmcnt(4)
    v_lshlrev_b32 v72, 16, v56
    v_and_b32 v73, 0xffff0000, v56
    v_lshlrev_b32 v74, 16, v32
    v_and_b32 v75, 0xffff0000, v32
    v_pk_mul_f32 v[72:73], v[72:73], v[74:75]
    v_cvt_pk_bf16_f32 v32, v72, v73
    v_lshlrev_b32 v72, 16, v57
    v_and_b32 v73, 0xffff0000, v57
    v_lshlrev_b32 v74, 16, v33
    v_and_b32 v75, 0xffff0000, v33
    v_pk_mul_f32 v[72:73], v[72:73], v[74:75]
    v_cvt_pk_bf16_f32 v33, v72, v73
    v_lshlrev_b32 v72, 16, v58
    v_and_b32 v73, 0xffff0000, v58
    v_lshlrev_b32 v74, 16, v34
    v_and_b32 v75, 0xffff0000, v34
    v_pk_mul_f32 v[72:73], v[72:73], v[74:75]
    v_cvt_pk_bf16_f32 v34, v72, v73
    v_lshlrev_b32 v72, 16, v59
    v_and_b32 v73, 0xffff0000, v59
    v_lshlrev_b32 v74, 16, v35
    v_and_b32 v75, 0xffff0000, v35
    v_pk_mul_f32 v[72:73], v[72:73], v[74:75]
    v_cvt_pk_bf16_f32 v35, v72, v73
    buffer_store_dwordx4 v[32:35], v20, s[36:39], s49 offen offset:0
    s_waitcnt lgkmcnt(2)
    v_lshlrev_b32 v72, 16, v60
    v_and_b32 v73, 0xffff0000, v60
    v_lshlrev_b32 v74, 16, v36
    v_and_b32 v75, 0xffff0000, v36
    v_pk_mul_f32 v[72:73], v[72:73], v[74:75]
    v_cvt_pk_bf16_f32 v36, v72, v73
    v_lshlrev_b32 v72, 16, v61
    v_and_b32 v73, 0xffff0000, v61
    v_lshlrev_b32 v74, 16, v37
    v_and_b32 v75, 0xffff0000, v37
    v_pk_mul_f32 v[72:73], v[72:73], v[74:75]
    v_cvt_pk_bf16_f32 v37, v72, v73
    v_lshlrev_b32 v72, 16, v62
    v_and_b32 v73, 0xffff0000, v62
    v_lshlrev_b32 v74, 16, v38
    v_and_b32 v75, 0xffff0000, v38
    v_pk_mul_f32 v[72:73], v[72:73], v[74:75]
    v_cvt_pk_bf16_f32 v38, v72, v73
    v_lshlrev_b32 v72, 16, v63
    v_and_b32 v73, 0xffff0000, v63
    v_lshlrev_b32 v74, 16, v39
    v_and_b32 v75, 0xffff0000, v39
    v_pk_mul_f32 v[72:73], v[72:73], v[74:75]
    v_cvt_pk_bf16_f32 v39, v72, v73
    buffer_store_dwordx4 v[36:39], v20, s[36:39], s49 offen offset:64
    s_waitcnt lgkmcnt(0)
    v_lshlrev_b32 v72, 16, v64
    v_and_b32 v73, 0xffff0000, v64
    v_lshlrev_b32 v74, 16, v40
    v_and_b32 v75, 0xffff0000, v40
    v_pk_mul_f32 v[72:73], v[72:73], v[74:75]
    v_cvt_pk_bf16_f32 v40, v72, v73
    v_lshlrev_b32 v72, 16, v65
    v_and_b32 v73, 0xffff0000, v65
    v_lshlrev_b32 v74, 16, v41
    v_and_b32 v75, 0xffff0000, v41
    v_pk_mul_f32 v[72:73], v[72:73], v[74:75]
    v_cvt_pk_bf16_f32 v41, v72, v73
    v_lshlrev_b32 v72, 16, v66
    v_and_b32 v73, 0xffff0000, v66
    v_lshlrev_b32 v74, 16, v42
    v_and_b32 v75, 0xffff0000, v42
    v_pk_mul_f32 v[72:73], v[72:73], v[74:75]
    v_cvt_pk_bf16_f32 v42, v72, v73
    v_lshlrev_b32 v72, 16, v67
    v_and_b32 v73, 0xffff0000, v67
    v_lshlrev_b32 v74, 16, v43
    v_and_b32 v75, 0xffff0000, v43
    v_pk_mul_f32 v[72:73], v[72:73], v[74:75]
    v_cvt_pk_bf16_f32 v43, v72, v73
    s_mov_b64 exec, 0xffff
    buffer_store_dwordx4 v[40:43], v20, s[36:39], s49 offen offset:128
    s_mov_b64 exec, -1
    s_cmp_lg_u32 s49, 1152
    s_cbranch_scc1 L_b3d
    s_mov_b32 s49, 38016
    v_add_u32 v19, 32, v19
    v_mov_b32 v32, v44
    v_mov_b32 v33, v45
    v_mov_b32 v34, v46
    v_mov_b32 v35, v47
    v_mov_b32 v36, v48
    v_mov_b32 v37, v49
    v_mov_b32 v38, v50
    v_mov_b32 v39, v51
    v_mov_b32 v40, v52
    v_mov_b32 v41, v53
    v_mov_b32 v42, v54
    v_mov_b32 v43, v55
    s_branch L_b3l
L_b3d:
    s_branch L_hfin
L_h01:
    s_cmp_eq_u32 s57, 0
    s_cbranch_scc1 L_h0
    v_mov_b32 v80, 157216
    s_waitcnt vmcnt(0)
    ds_write_b32 v12, v13 offset:36
    v_and_b32 v27, 7, v2
    v_lshlrev_b32 v27, 2, v27
    v_add_u32 v27, 157248, v27
    s_mov_b32 s59, 262144
L_ytp:
    ds_read_b32 v25, v27 offset:0
    s_waitcnt lgkmcnt(0)
    v_cmp_eq_u32 vcc, 0, v25
    s_nop 0
    s_cbranch_vccz L_ytd
    s_sleep 1
    s_sub_u32 s59, s59, 1
    s_cmp_lg_u32 s59, 0
    s_cbranch_scc1 L_ytp
L_ytd:
    s_mov_b32 exec_hi, 15
    buffer_load_dwordx4 v[72:75], v23, s[28:31], s46 offen sc1
    s_waitcnt vmcnt(0)
    ds_write_b32 v12, v13 offset:36
    v_min3_u32 v76, v72, v73, v74
    v_max3_u32 v77, v72, v73, v74
    v_min_u32 v76, v76, v75
    v_max_u32 v77, v77, v75
    v_cmp_ne_u32 vcc, s45, v76
    v_cmp_ne_u32 s[60:61], s45, v77
    s_or_b64 vcc, vcc, s[60:61]
    s_cbranch_vccz L_ypd
    s_mov_b64 exec, vcc
    s_mov_b32 s59, 262144
L_ypp:
    v_mov_b32 v72, 0
    v_mov_b32 v73, 0
    v_mov_b32 v74, 0
    v_mov_b32 v75, 0
    buffer_atomic_or_x2 v[72:73], v23, s[28:31], s46 offen sc0 sc1
    buffer_atomic_or_x2 v[74:75], v23, s[28:31], s46 offen offset:8 sc0 sc1
    s_waitcnt vmcnt(0)
    ds_write_b32 v12, v13 offset:36
    v_min3_u32 v76, v72, v73, v74
    v_max3_u32 v77, v72, v73, v74
    v_min_u32 v76, v76, v75
    v_max_u32 v77, v77, v75
    v_cmp_ne_u32 vcc, s45, v76
    v_cmp_ne_u32 s[60:61], s45, v77
    s_or_b64 vcc, vcc, s[60:61]
    s_cbranch_vccz L_ypd
    s_mov_b64 exec, vcc
    s_cbranch_vccz L_ypd
    s_sleep 8
    s_sub_u32 s59, s59, 1
    s_cmp_lg_u32 s59, 0
    s_cbranch_scc1 L_ypp
L_ypd:
    s_mov_b64 exec, -1
    ds_write_b32 v80, v13
    s_branch L_hfin
L_h0:
    s_waitcnt vmcnt(0)
    ds_write_b32 v12, v13 offset:36
    s_lshl_b32 s47, s95, 1
    v_add_u32 v24, s47, v2
    v_and_b32 v24, 15, v24
    v_and_b32 v25, 48, v2
    v_or_b32 v24, v24, v25
    s_lshl_b32 s46, s94, 10
    v_lshlrev_b32 v24, 4, v24
    s_add_u32 s46, s46, 23592960
    v_mov_b32 v26, 157312
    v_and_b32 v27, 7, v2
    v_lshlrev_b32 v27, 2, v27
    v_add_u32 v27, 157248, v27
    s_mov_b32 s59, 262144
L_otp:
    ds_read_b32 v25, v27 offset:0
    s_waitcnt lgkmcnt(0)
    v_cmp_eq_u32 vcc, 0, v25
    s_nop 0
    s_cbranch_vccz L_otd
    s_sleep 1
    s_sub_u32 s59, s59, 1
    s_cmp_lg_u32 s59, 0
    s_cbranch_scc1 L_otp
L_otd:
    s_mov_b32 s59, 262144
L_hop:
    v_mov_b32 v25, 0
    buffer_atomic_or v25, v24, s[28:31], s46 offen sc0 sc1
    s_waitcnt vmcnt(0)
    v_cmp_ne_u32 vcc, s45, v25
    s_not_b64 s[48:49], vcc
    v_mov_b32 v72, s48
    v_mov_b32 v73, s49
    ds_write_b64 v26, v[72:73]
    s_cbranch_vccz L_hod
    s_mov_b64 exec, vcc
    s_cbranch_vccz L_hod
    s_sleep 2
    s_sub_u32 s59, s59, 1
    s_cmp_lg_u32 s59, 0
    s_cbranch_scc1 L_hop
L_hod:
    s_mov_b64 exec, -1
L_hfin:
    s_cmp_lg_u32 s2, 0
    s_cbranch_scc1 L_end
    s_cmp_lg_u32 s44, 9
    s_cbranch_scc1 L_end
    v_lshlrev_b32 v8, 7, v2
    s_mov_b32 s46, 23134208
    s_mov_b32 s47, 23142400
    s_mov_b32 s48, 23150592
    s_mov_b32 s49, 23158784
    s_mov_b32 s59, 262144
L_epp:
    buffer_load_dword v72, v8, s[28:31], s46 offen sc1
    buffer_load_dword v73, v8, s[28:31], s47 offen sc1
    buffer_load_dword v74, v8, s[28:31], s48 offen sc1
    buffer_load_dword v75, v8, s[28:31], s49 offen sc1
    s_waitcnt vmcnt(0)
    v_min3_u32 v76, v72, v73, v74
    v_max3_u32 v77, v72, v73, v74
    v_min_u32 v76, v76, v75
    v_max_u32 v77, v77, v75
    v_cmp_ne_u32 vcc, s45, v76
    v_cmp_ne_u32 s[60:61], s45, v77
    s_or_b64 vcc, vcc, s[60:61]
    s_cbranch_vccz L_epd
    s_sleep 4
    s_sub_u32 s59, s59, 1
    s_cmp_lg_u32 s59, 0
    s_cbranch_scc1 L_epp
L_epd:
    v_mov_b32 v8, 23068672
    v_mov_b32 v9, s45
    s_mov_b64 exec, 1
    buffer_store_dword v9, v8, s[28:31], 0 offen sc1
    s_mov_b64 exec, -1
    s_endpgm
L_cconv:
Wa8:
    s_cbranch_execz Wa9
    s_cmp_lg_u32 s69, 0
    s_cbranch_scc1 L_noconv
    v_mov_b32 v16, 0
    v_mov_b32 v17, 0
    v_mov_b32 v18, 0
    v_mov_b32 v19, 0
    v_mov_b32 v20, 0
    v_mov_b32 v21, 0
    v_mov_b32 v22, 0
    v_mov_b32 v23, 0
    v_mov_b32 v24, 0
    v_mov_b32 v25, 0
    v_mov_b32 v26, 0
    v_mov_b32 v27, 0
    v_mov_b32 v28, 0
    v_mov_b32 v29, 0
    v_mov_b32 v30, 0
    v_mov_b32 v31, 0
    v_mov_b32 v32, 0
    v_mov_b32 v33, 0
    v_mov_b32 v34, 0
    v_mov_b32 v35, 0
    v_mov_b32 v36, 0
    v_mov_b32 v37, 0
    v_mov_b32 v38, 0
    v_mov_b32 v39, 0
    v_mov_b32 v40, 0
    v_mov_b32 v41, 0
    v_mov_b32 v42, 0
    v_mov_b32 v43, 0
    v_mov_b32 v44, 0
    v_mov_b32 v45, 0
    v_mov_b32 v46, 0
    v_mov_b32 v47, 0
    v_mov_b32 v5, 1
    ds_write_b32 v10, v5 offset:208
    s_barrier
    ds_read_b64 v[48:49], v8 offset:3584
    ds_read_b64 v[50:51], v8 offset:3592
    ds_read_b128 v[52:55], v9 offset:0
    ds_read_b64 v[56:57], v8 offset:3072
    ds_read_b64 v[58:59], v8 offset:3080
    ds_read_b128 v[60:63], v9 offset:512
    ds_read_b64 v[64:65], v8 offset:2560
    ds_read_b64 v[66:67], v8 offset:2568
    ds_read_b128 v[68:71], v9 offset:1024
    ds_read_b64 v[72:73], v8 offset:2048
    ds_read_b64 v[74:75], v8 offset:2056
    ds_read_b128 v[76:79], v9 offset:1536
    s_mov_b32 s51, 2
    .p2align 6
L_cvlp:
    s_waitcnt lgkmcnt(0)
    v_mfma_f32_16x16x32_bf16 v[16:19], v[48:51], v[52:55], v[16:19]
    ds_read_b64 v[112:113], v8 offset:1536
    v_mfma_f32_16x16x32_bf16 v[20:23], v[48:51], v[60:63], v[20:23]
    ds_read_b64 v[114:115], v8 offset:1544
    v_mfma_f32_16x16x32_bf16 v[24:27], v[48:51], v[68:71], v[24:27]
    ds_read_b128 v[116:119], v9 offset:2048
    v_mfma_f32_16x16x32_bf16 v[28:31], v[48:51], v[76:79], v[28:31]
    ds_read_b64 v[120:121], v8 offset:1024
    v_mfma_f32_16x16x32_bf16 v[20:23], v[56:59], v[52:55], v[20:23]
    ds_read_b64 v[122:123], v8 offset:1032
    v_mfma_f32_16x16x32_bf16 v[24:27], v[56:59], v[60:63], v[24:27]
    ds_read_b128 v[124:127], v9 offset:2560
    v_mfma_f32_16x16x32_bf16 v[28:31], v[56:59], v[68:71], v[28:31]
    ds_read_b64 v[128:129], v8 offset:512
    v_mfma_f32_16x16x32_bf16 v[32:35], v[56:59], v[76:79], v[32:35]
    ds_read_b64 v[130:131], v8 offset:520
    v_mfma_f32_16x16x32_bf16 v[24:27], v[64:67], v[52:55], v[24:27]
    ds_read_b128 v[132:135], v9 offset:3072
    v_mfma_f32_16x16x32_bf16 v[28:31], v[64:67], v[60:63], v[28:31]
    ds_read_b64 v[136:137], v8 offset:0
    v_mfma_f32_16x16x32_bf16 v[32:35], v[64:67], v[68:71], v[32:35]
    ds_read_b64 v[138:139], v8 offset:8
    v_mfma_f32_16x16x32_bf16 v[36:39], v[64:67], v[76:79], v[36:39]
    ds_read_b128 v[140:143], v9 offset:3584
    v_mfma_f32_16x16x32_bf16 v[28:31], v[72:75], v[52:55], v[28:31]
    v_mfma_f32_16x16x32_bf16 v[32:35], v[72:75], v[60:63], v[32:35]
    v_mfma_f32_16x16x32_bf16 v[36:39], v[72:75], v[68:71], v[36:39]
    v_mfma_f32_16x16x32_bf16 v[40:43], v[72:75], v[76:79], v[40:43]
    v_subrev_u32 v8, 64, v8
Wa9:
    s_cbranch_execz Wa10
    v_subrev_u32 v9, 64, v9
    s_waitcnt lgkmcnt(0)
    v_mfma_f32_16x16x32_bf16 v[32:35], v[112:115], v[52:55], v[32:35]
    ds_read_b64 v[80:81], v8 offset:3584
    v_mfma_f32_16x16x32_bf16 v[36:39], v[112:115], v[60:63], v[36:39]
    ds_read_b64 v[82:83], v8 offset:3592
    v_mfma_f32_16x16x32_bf16 v[40:43], v[112:115], v[68:71], v[40:43]
    ds_read_b128 v[84:87], v9 offset:0
    v_mfma_f32_16x16x32_bf16 v[44:47], v[112:115], v[76:79], v[44:47]
    ds_read_b64 v[88:89], v8 offset:3072
    v_mfma_f32_16x16x32_bf16 v[36:39], v[120:123], v[52:55], v[36:39]
    ds_read_b64 v[90:91], v8 offset:3080
    v_mfma_f32_16x16x32_bf16 v[40:43], v[120:123], v[60:63], v[40:43]
    ds_read_b128 v[92:95], v9 offset:512
    v_mfma_f32_16x16x32_bf16 v[44:47], v[120:123], v[68:71], v[44:47]
    ds_read_b64 v[96:97], v8 offset:2560
    v_mfma_f32_16x16x32_bf16 v[40:43], v[128:131], v[52:55], v[40:43]
    ds_read_b64 v[98:99], v8 offset:2568
    v_mfma_f32_16x16x32_bf16 v[44:47], v[128:131], v[60:63], v[44:47]
    ds_read_b128 v[100:103], v9 offset:1024
    v_mfma_f32_16x16x32_bf16 v[44:47], v[136:139], v[52:55], v[44:47]
    ds_read_b64 v[104:105], v8 offset:2048
    v_mfma_f32_16x16x32_bf16 v[32:35], v[48:51], v[116:119], v[32:35]
    ds_read_b64 v[106:107], v8 offset:2056
    v_mfma_f32_16x16x32_bf16 v[36:39], v[56:59], v[116:119], v[36:39]
    ds_read_b128 v[108:111], v9 offset:1536
    v_mfma_f32_16x16x32_bf16 v[40:43], v[64:67], v[116:119], v[40:43]
    v_mfma_f32_16x16x32_bf16 v[44:47], v[72:75], v[116:119], v[44:47]
    v_mfma_f32_16x16x32_bf16 v[36:39], v[48:51], v[124:127], v[36:39]
    v_mfma_f32_16x16x32_bf16 v[40:43], v[56:59], v[124:127], v[40:43]
    v_mfma_f32_16x16x32_bf16 v[44:47], v[64:67], v[124:127], v[44:47]
    v_mfma_f32_16x16x32_bf16 v[40:43], v[48:51], v[132:135], v[40:43]
    v_mfma_f32_16x16x32_bf16 v[44:47], v[56:59], v[132:135], v[44:47]
    v_mfma_f32_16x16x32_bf16 v[44:47], v[48:51], v[140:143], v[44:47]
    s_cmp_lt_i32 s3, 0
    s_cbranch_scc1 L_cvnf
    s_waitcnt vmcnt(0)
    v_mov_b32 v6, s3
    v_mov_b32 v7, s45
    s_mov_b64 exec, 1
    buffer_store_dword v7, v6, s[28:31], 0 offen sc1
    s_mov_b64 exec, -1
    s_mov_b32 s3, 0x80000000
L_cvnf:
    s_waitcnt lgkmcnt(0)
    v_mfma_f32_16x16x32_bf16 v[16:19], v[80:83], v[84:87], v[16:19]
    ds_read_b64 v[112:113], v8 offset:1536
    v_mfma_f32_16x16x32_bf16 v[20:23], v[80:83], v[92:95], v[20:23]
    ds_read_b64 v[114:115], v8 offset:1544
    v_mfma_f32_16x16x32_bf16 v[24:27], v[80:83], v[100:103], v[24:27]
    ds_read_b128 v[116:119], v9 offset:2048
    v_mfma_f32_16x16x32_bf16 v[28:31], v[80:83], v[108:111], v[28:31]
    ds_read_b64 v[120:121], v8 offset:1024
    v_mfma_f32_16x16x32_bf16 v[20:23], v[88:91], v[84:87], v[20:23]
    ds_read_b64 v[122:123], v8 offset:1032
    v_mfma_f32_16x16x32_bf16 v[24:27], v[88:91], v[92:95], v[24:27]
    ds_read_b128 v[124:127], v9 offset:2560
    v_mfma_f32_16x16x32_bf16 v[28:31], v[88:91], v[100:103], v[28:31]
    ds_read_b64 v[128:129], v8 offset:512
    v_mfma_f32_16x16x32_bf16 v[32:35], v[88:91], v[108:111], v[32:35]
    ds_read_b64 v[130:131], v8 offset:520
    v_mfma_f32_16x16x32_bf16 v[24:27], v[96:99], v[84:87], v[24:27]
    ds_read_b128 v[132:135], v9 offset:3072
    v_mfma_f32_16x16x32_bf16 v[28:31], v[96:99], v[92:95], v[28:31]
    ds_read_b64 v[136:137], v8 offset:0
    v_mfma_f32_16x16x32_bf16 v[32:35], v[96:99], v[100:103], v[32:35]
    ds_read_b64 v[138:139], v8 offset:8
    v_mfma_f32_16x16x32_bf16 v[36:39], v[96:99], v[108:111], v[36:39]
    ds_read_b128 v[140:143], v9 offset:3584
    v_mfma_f32_16x16x32_bf16 v[28:31], v[104:107], v[84:87], v[28:31]
    v_mfma_f32_16x16x32_bf16 v[32:35], v[104:107], v[92:95], v[32:35]
    v_mfma_f32_16x16x32_bf16 v[36:39], v[104:107], v[100:103], v[36:39]
    v_mfma_f32_16x16x32_bf16 v[40:43], v[104:107], v[108:111], v[40:43]
    v_subrev_u32 v8, 64, v8
    v_subrev_u32 v9, 64, v9
    s_waitcnt lgkmcnt(0)
    v_mfma_f32_16x16x32_bf16 v[32:35], v[112:115], v[84:87], v[32:35]
    ds_read_b64 v[48:49], v8 offset:3584
    v_mfma_f32_16x16x32_bf16 v[36:39], v[112:115], v[92:95], v[36:39]
    ds_read_b64 v[50:51], v8 offset:3592
    v_mfma_f32_16x16x32_bf16 v[40:43], v[112:115], v[100:103], v[40:43]
Wa10:
    s_cbranch_execz Wa11
    ds_read_b128 v[52:55], v9 offset:0
    v_mfma_f32_16x16x32_bf16 v[44:47], v[112:115], v[108:111], v[44:47]
    ds_read_b64 v[56:57], v8 offset:3072
    v_mfma_f32_16x16x32_bf16 v[36:39], v[120:123], v[84:87], v[36:39]
    ds_read_b64 v[58:59], v8 offset:3080
    v_mfma_f32_16x16x32_bf16 v[40:43], v[120:123], v[92:95], v[40:43]
    ds_read_b128 v[60:63], v9 offset:512
    v_mfma_f32_16x16x32_bf16 v[44:47], v[120:123], v[100:103], v[44:47]
    ds_read_b64 v[64:65], v8 offset:2560
    v_mfma_f32_16x16x32_bf16 v[40:43], v[128:131], v[84:87], v[40:43]
    ds_read_b64 v[66:67], v8 offset:2568
    v_mfma_f32_16x16x32_bf16 v[44:47], v[128:131], v[92:95], v[44:47]
    ds_read_b128 v[68:71], v9 offset:1024
    v_mfma_f32_16x16x32_bf16 v[44:47], v[136:139], v[84:87], v[44:47]
    ds_read_b64 v[72:73], v8 offset:2048
    v_mfma_f32_16x16x32_bf16 v[32:35], v[80:83], v[116:119], v[32:35]
    ds_read_b64 v[74:75], v8 offset:2056
    v_mfma_f32_16x16x32_bf16 v[36:39], v[88:91], v[116:119], v[36:39]
    ds_read_b128 v[76:79], v9 offset:1536
    v_mfma_f32_16x16x32_bf16 v[40:43], v[96:99], v[116:119], v[40:43]
    v_mfma_f32_16x16x32_bf16 v[44:47], v[104:107], v[116:119], v[44:47]
    v_mfma_f32_16x16x32_bf16 v[36:39], v[80:83], v[124:127], v[36:39]
    v_mfma_f32_16x16x32_bf16 v[40:43], v[88:91], v[124:127], v[40:43]
    v_mfma_f32_16x16x32_bf16 v[44:47], v[96:99], v[124:127], v[44:47]
    v_mfma_f32_16x16x32_bf16 v[40:43], v[80:83], v[132:135], v[40:43]
    v_mfma_f32_16x16x32_bf16 v[44:47], v[88:91], v[132:135], v[44:47]
    v_mfma_f32_16x16x32_bf16 v[44:47], v[80:83], v[140:143], v[44:47]
    s_sub_u32 s51, s51, 1
    s_cmp_lg_u32 s51, 0
    s_cbranch_scc1 L_cvlp
    ds_read_b64 v[112:113], v11 offset:0
    ds_read_b64 v[114:115], v11 offset:512
    ds_read_b64 v[116:117], v11 offset:1024
    ds_read_b64 v[118:119], v11 offset:1536
    v_xor_b32 v8, 4, v10
    v_mov_b32 v9, 1
    s_cmp_lg_u32 s90, 0
    s_cbranch_scc1 L_cvx1
    ds_write_b128 v12, v[32:35] offset:0
    ds_write_b128 v12, v[36:39] offset:1024
    ds_write_b128 v12, v[40:43] offset:2048
    ds_write_b128 v12, v[44:47] offset:3072
    s_waitcnt lgkmcnt(0)
    ds_write_b32 v10, v9
    v_lshlrev_b32 v80, 16, v112
    v_and_b32 v81, 0xffff0000, v112
    v_fma_f32 v96, v80, s88, v16
    v_fma_f32 v97, v81, s88, v17
    v_lshlrev_b32 v80, 16, v113
    v_and_b32 v81, 0xffff0000, v113
    v_fma_f32 v98, v80, s88, v18
    v_fma_f32 v99, v81, s88, v19
    v_lshlrev_b32 v80, 16, v114
    v_and_b32 v81, 0xffff0000, v114
    v_fma_f32 v100, v80, s88, v20
    v_fma_f32 v101, v81, s88, v21
    v_lshlrev_b32 v80, 16, v115
    v_and_b32 v81, 0xffff0000, v115
    v_fma_f32 v102, v80, s88, v22
    v_fma_f32 v103, v81, s88, v23
    v_lshlrev_b32 v80, 16, v116
    v_and_b32 v81, 0xffff0000, v116
    v_fma_f32 v104, v80, s88, v24
    v_fma_f32 v105, v81, s88, v25
    v_lshlrev_b32 v80, 16, v117
    v_and_b32 v81, 0xffff0000, v117
    v_fma_f32 v106, v80, s88, v26
    v_fma_f32 v107, v81, s88, v27
    v_lshlrev_b32 v80, 16, v118
    v_and_b32 v81, 0xffff0000, v118
    v_fma_f32 v108, v80, s88, v28
    v_fma_f32 v109, v81, s88, v29
    v_lshlrev_b32 v80, 16, v119
    v_and_b32 v81, 0xffff0000, v119
    v_fma_f32 v110, v80, s88, v30
    v_fma_f32 v111, v81, s88, v31
    s_branch L_cvst
L_cvx1:
    s_nop 3
    ds_write_b128 v12, v[16:19] offset:0
    ds_write_b128 v12, v[20:23] offset:1024
Wa11:
    s_cbranch_execz L_wret0
    ds_write_b128 v12, v[24:27] offset:2048
    ds_write_b128 v12, v[28:31] offset:3072
    s_waitcnt lgkmcnt(0)
    ds_write_b32 v10, v9
    v_lshlrev_b32 v80, 16, v112
    v_and_b32 v81, 0xffff0000, v112
    v_fma_f32 v96, v80, s88, v32
    v_fma_f32 v97, v81, s88, v33
    v_lshlrev_b32 v80, 16, v113
    v_and_b32 v81, 0xffff0000, v113
    v_fma_f32 v98, v80, s88, v34
    v_fma_f32 v99, v81, s88, v35
    v_lshlrev_b32 v80, 16, v114
    v_and_b32 v81, 0xffff0000, v114
    v_fma_f32 v100, v80, s88, v36
    v_fma_f32 v101, v81, s88, v37
    v_lshlrev_b32 v80, 16, v115
    v_and_b32 v81, 0xffff0000, v115
    v_fma_f32 v102, v80, s88, v38
    v_fma_f32 v103, v81, s88, v39
    v_lshlrev_b32 v80, 16, v116
    v_and_b32 v81, 0xffff0000, v116
    v_fma_f32 v104, v80, s88, v40
    v_fma_f32 v105, v81, s88, v41
    v_lshlrev_b32 v80, 16, v117
    v_and_b32 v81, 0xffff0000, v117
    v_fma_f32 v106, v80, s88, v42
    v_fma_f32 v107, v81, s88, v43
    v_lshlrev_b32 v80, 16, v118
    v_and_b32 v81, 0xffff0000, v118
    v_fma_f32 v108, v80, s88, v44
    v_fma_f32 v109, v81, s88, v45
    v_lshlrev_b32 v80, 16, v119
    v_and_b32 v81, 0xffff0000, v119
    v_fma_f32 v110, v80, s88, v46
    v_fma_f32 v111, v81, s88, v47
L_cvst:
    s_mov_b32 s59, 262144
L_cvwp:
    ds_read_b32 v9, v8 offset:0
    s_waitcnt lgkmcnt(0)
    v_cmp_eq_u32 vcc, 0, v9
    s_nop 0
    s_cbranch_vccz L_cvwd
    s_sub_u32 s59, s59, 1
    s_cmp_lg_u32 s59, 0
    s_cbranch_scc1 L_cvwp
L_cvwd:
    ds_read_b128 v[16:19], v13 offset:0
    ds_read_b128 v[20:23], v13 offset:1024
    ds_read_b128 v[24:27], v13 offset:2048
    ds_read_b128 v[28:31], v13 offset:3072
    s_waitcnt lgkmcnt(2)
    v_pk_add_f32 v[96:97], v[96:97], v[16:17]
    v_pk_add_f32 v[98:99], v[98:99], v[18:19]
    v_pk_add_f32 v[100:101], v[100:101], v[20:21]
    v_pk_add_f32 v[102:103], v[102:103], v[22:23]
    v_cvt_pk_bf16_f32 v128, v96, v97
    v_cvt_pk_bf16_f32 v129, v98, v99
    v_cvt_pk_bf16_f32 v130, v100, v101
    v_cvt_pk_bf16_f32 v131, v102, v103
    s_nop 0
    v_permlane16_swap_b32 v128, v130
    v_permlane16_swap_b32 v129, v131
    buffer_store_dwordx4 v[128:131], v14, s[28:31], s89 offen offset:0 sc1
    s_waitcnt lgkmcnt(0)
    v_pk_add_f32 v[104:105], v[104:105], v[24:25]
    v_pk_add_f32 v[106:107], v[106:107], v[26:27]
    v_pk_add_f32 v[108:109], v[108:109], v[28:29]
    v_pk_add_f32 v[110:111], v[110:111], v[30:31]
    v_cvt_pk_bf16_f32 v132, v104, v105
    v_cvt_pk_bf16_f32 v133, v106, v107
    v_cvt_pk_bf16_f32 v134, v108, v109
    v_cvt_pk_bf16_f32 v135, v110, v111
    s_nop 0
    v_permlane16_swap_b32 v132, v134
    v_permlane16_swap_b32 v133, v135
    buffer_store_dwordx4 v[132:135], v14, s[28:31], s89 offen offset:1024 sc1
    s_cmp_lg_u32 s97, 0
    s_cbranch_scc1 L_qpoll
    s_lshl_b32 s47, s44, 11
    s_add_u32 s47, s47, 32768
    v_lshlrev_b32 v4, 4, v2
Wa12:
    s_cbranch_execz Wa13
    v_add_u32 v4, s47, v4
    s_mov_b32 s59, 262144
L_qrp:
    ds_read_b32 v5, v10 offset:240
    s_waitcnt lgkmcnt(0)
    v_cmp_eq_u32 vcc, 0, v5
    s_nop 0
    s_cbranch_vccz L_qrd
    s_sub_u32 s59, s59, 1
    s_cmp_lg_u32 s59, 0
    s_cbranch_scc1 L_qrp
L_qrd:
    ds_read_b128 v[144:147], v4
    ds_read_b128 v[148:151], v4 offset:1024
    v_mov_b32 v5, 1
    s_waitcnt lgkmcnt(0)
    ds_write_b32 v10, v5 offset:160
    s_branch L_qhave
L_noconv:
    s_barrier
    s_waitcnt vmcnt(0)
    v_mov_b32 v6, s3
    v_mov_b32 v7, s45
    s_mov_b64 exec, 1
    buffer_store_dword v7, v6, s[28:31], 0 offen sc1
    s_mov_b64 exec, -1
    v_mov_b32 v5, 1
    ds_write_b32 v10, v5 offset:208
    v_bfe_u32 v6, v2, 2, 1
    v_lshlrev_b32 v6, 8, v6
    v_add_u32 v6, v6, v167
    s_sub_u32 s48, s63, 256
    s_mov_b32 s59, 262144
L_qhp:
    v_mov_b32 v136, s45
    s_mov_b64 exec, 85
    v_mov_b32 v136, 0
    buffer_atomic_or v136, v6, s[28:31], s48 offen sc0 sc1
    s_mov_b64 exec, -1
    s_waitcnt vmcnt(0)
    v_cmp_ne_u32 vcc, s45, v136
    s_nop 0
    s_cbranch_vccz L_qhd
    s_sleep 4
    s_sub_u32 s59, s59, 1
    s_cmp_lg_u32 s59, 0
    s_cbranch_scc1 L_qhp
L_qhd:
    v_and_b32 v4, 0x7fff, v166
    s_lshl_b32 s47, s44, 11
    s_add_u32 m0, s47, 24576
    s_sub_u32 s48, s61, 2048
    buffer_load_dwordx4 v166, s[28:31], s48 offen sc1 lds
    s_add_u32 m0, s47, 25600
    s_sub_u32 s48, s62, 2048
    buffer_load_dwordx4 v4, s[28:31], s48 offen sc1 lds
    v_and_b32 v4, 0x7fff, v166
    buffer_load_dwordx4 v[144:147], v166, s[28:31], s61 offen sc1
    buffer_load_dwordx4 v[148:151], v4, s[28:31], s62 offen sc1
    v_mov_b32 v5, 1
    ds_write_b32 v10, v5 offset:160
    s_waitcnt vmcnt(2)
    ds_write_b32 v10, v5 offset:224
    s_waitcnt vmcnt(0)
    s_branch L_qhave
L_qpoll:
    s_mov_b32 s59, 262144
L_qgp:
    v_mov_b32 v5, s45
    s_mov_b64 exec, 5
    v_mov_b32 v5, 0
    buffer_atomic_or v5, v167, s[28:31], s63 offen sc0 sc1
    s_mov_b64 exec, -1
    s_waitcnt vmcnt(0)
    v_cmp_ne_u32 vcc, s45, v5
    s_nop 0
    s_cbranch_vccz L_qgd
    s_sleep 4
    s_sub_u32 s59, s59, 1
    s_cmp_lg_u32 s59, 0
    s_cbranch_scc1 L_qgp
L_qgd:
    v_and_b32 v4, 0x7fff, v166
    buffer_load_dwordx4 v[144:147], v166, s[28:31], s61 offen sc1
    buffer_load_dwordx4 v[148:151], v4, s[28:31], s62 offen sc1
    v_mov_b32 v5, 1
    ds_write_b32 v10, v5 offset:160
    s_waitcnt vmcnt(0)
L_qhave:
Wa13:
    s_cbranch_execz L_wret0
    v_bfe_i32 v40, v165, 0, 1
    v_bfe_i32 v41, v165, 1, 1
    v_bfe_i32 v42, v165, 2, 1
    v_bfe_i32 v43, v165, 3, 1
    v_bfe_i32 v44, v165, 4, 1
    v_bfe_i32 v45, v165, 5, 1
    v_bfe_i32 v46, v165, 6, 1
    v_bfe_i32 v47, v165, 7, 1
    v_and_b32 v144, v144, v40
    v_and_b32 v145, v145, v41
    v_and_b32 v146, v146, v42
    v_and_b32 v147, v147, v43
    v_and_b32 v148, v148, v44
    v_and_b32 v149, v149, v45
    v_and_b32 v150, v150, v46
    v_and_b32 v151, v151, v47
    s_mov_b32 s55, 0
    v_and_b32 v18, 3, v2
    v_lshlrev_b32 v18, 2, v18
    v_add_u32 v18, 157184, v18
    s_mov_b32 s59, 262144
L_ownp:
    ds_read_b32 v19, v18 offset:144
    s_waitcnt lgkmcnt(0)
    v_cmp_eq_u32 vcc, 0, v19
    s_nop 0
    s_cbranch_vccz L_ownd
    s_sub_u32 s59, s59, 1
    s_cmp_lg_u32 s59, 0
    s_cbranch_scc1 L_ownp
L_ownd:
L_atstart:
    ds_read_b128 v[88:91], v160 offset:4096
    ds_read_b128 v[92:95], v161 offset:4096
    ds_read_b128 v[96:99], v160 offset:3584
    ds_read_b128 v[100:103], v161 offset:3584
    ds_read_b64_tr_b16 v[104:105], v162 offset:4096
    ds_read_b64_tr_b16 v[106:107], v162 offset:4224
    ds_read_b64_tr_b16 v[108:109], v162 offset:4352
    ds_read_b64_tr_b16 v[110:111], v162 offset:4480
    s_waitcnt lgkmcnt(6)
    v_mfma_f32_32x32x16_bf16 v[56:71], v[88:91], v[144:147], 0
    s_cmp_lg_u32 s55, 0
    s_cbranch_scc1 L_athave
    v_dot2_f32_bf16 v16, v144, v88, 0
    v_dot2_f32_bf16 v17, v148, v92, 0
    v_dot2_f32_bf16 v16, v145, v89, v16
    v_dot2_f32_bf16 v17, v149, v93, v17
    v_dot2_f32_bf16 v16, v146, v90, v16
    v_dot2_f32_bf16 v17, v150, v94, v17
    v_dot2_f32_bf16 v16, v147, v91, v16
    v_dot2_f32_bf16 v17, v151, v95, v17
    s_waitcnt lgkmcnt(4)
    v_mfma_f32_32x32x16_bf16 v[72:87], v[96:99], v[144:147], 0
    s_nop 0
    v_add_f32 v16, v16, v17
    v_mov_b32 v17, v16
    s_nop 1
    v_permlane32_swap_b32 v17, v16
    s_mov_b32 exec_lo, 0
    v_add_f32 v16, -v16, -v17
    v_lshrrev_b32 v148, 16, v16
    s_mov_b32 exec_lo, -1
    s_branch L_atgo
L_athave:
    s_waitcnt lgkmcnt(4)
    v_mfma_f32_32x32x16_bf16 v[72:87], v[96:99], v[144:147], 0
L_atgo:
    v_mfma_f32_32x32x16_bf16 v[56:71], v[92:95], v[148:151], v[56:71]
    v_mfma_f32_32x32x16_bf16 v[72:87], v[100:103], v[148:151], v[72:87]
    ds_read_b128 v[88:91], v160 offset:3072
    ds_read_b128 v[92:95], v161 offset:3072
    s_nop 8
    v_exp_f32 v56, v56
    v_exp_f32 v57, v57
    v_exp_f32 v58, v58
    v_exp_f32 v59, v59
    v_exp_f32 v60, v60
    v_exp_f32 v61, v61
    v_exp_f32 v62, v62
    v_exp_f32 v63, v63
    v_cvt_pk_bf16_f32 v120, v56, v57
    v_cvt_pk_bf16_f32 v121, v58, v59
    v_cvt_pk_bf16_f32 v122, v60, v61
    v_cvt_pk_bf16_f32 v123, v62, v63
    v_and_b32 v120, v120, v152
    v_and_b32 v121, v121, v153
    v_and_b32 v122, v122, v154
    v_and_b32 v123, v123, v155
    v_exp_f32 v64, v64
    v_exp_f32 v65, v65
    s_waitcnt lgkmcnt(2)
    v_mfma_f32_32x32x16_bf16 v[40:55], v[104:107], v[120:123], 0
    ds_read_b64_tr_b16 v[112:113], v162 offset:3584
    ds_read_b64_tr_b16 v[114:115], v162 offset:3712
    ds_read_b64_tr_b16 v[116:117], v162 offset:3840
    ds_read_b64_tr_b16 v[118:119], v162 offset:3968
    v_exp_f32 v66, v66
    v_exp_f32 v67, v67
    v_exp_f32 v68, v68
    v_exp_f32 v69, v69
    v_exp_f32 v70, v70
    v_exp_f32 v71, v71
    v_cvt_pk_bf16_f32 v124, v64, v65
    v_cvt_pk_bf16_f32 v125, v66, v67
    v_cvt_pk_bf16_f32 v126, v68, v69
    v_cvt_pk_bf16_f32 v127, v70, v71
    v_and_b32 v124, v124, v156
    v_and_b32 v125, v125, v157
    v_and_b32 v126, v126, v158
    v_and_b32 v127, v127, v159
    s_cmp_eq_u32 s60, 0
    s_nop 0
    v_mfma_f32_32x32x16_bf16 v[40:55], v[108:111], v[124:127], v[40:55]
    s_cbranch_scc1 L_atfin
    v_exp_f32 v72, v72
    v_exp_f32 v73, v73
    v_exp_f32 v74, v74
    v_exp_f32 v75, v75
    s_waitcnt lgkmcnt(4)
    v_mfma_f32_32x32x16_bf16 v[56:71], v[88:91], v[144:147], 0
    v_exp_f32 v76, v76
    v_exp_f32 v77, v77
    v_exp_f32 v78, v78
    v_exp_f32 v79, v79
    v_mfma_f32_32x32x16_bf16 v[56:71], v[92:95], v[148:151], v[56:71]
    ds_read_b128 v[96:99], v160 offset:2560
    ds_read_b128 v[100:103], v161 offset:2560
    v_cvt_pk_bf16_f32 v120, v72, v73
    v_cvt_pk_bf16_f32 v121, v74, v75
    v_cvt_pk_bf16_f32 v122, v76, v77
    v_cvt_pk_bf16_f32 v123, v78, v79
    v_exp_f32 v80, v80
    v_exp_f32 v81, v81
    s_waitcnt lgkmcnt(2)
    v_mfma_f32_32x32x16_bf16 v[40:55], v[112:115], v[120:123], v[40:55]
    ds_read_b64_tr_b16 v[104:105], v162 offset:3072
    ds_read_b64_tr_b16 v[106:107], v162 offset:3200
    ds_read_b64_tr_b16 v[108:109], v162 offset:3328
    ds_read_b64_tr_b16 v[110:111], v162 offset:3456
    v_exp_f32 v82, v82
    v_exp_f32 v83, v83
    v_exp_f32 v84, v84
    v_exp_f32 v85, v85
    v_exp_f32 v86, v86
    v_exp_f32 v87, v87
    v_cvt_pk_bf16_f32 v124, v80, v81
    v_cvt_pk_bf16_f32 v125, v82, v83
    v_cvt_pk_bf16_f32 v126, v84, v85
    v_cvt_pk_bf16_f32 v127, v86, v87
    s_cmp_eq_u32 s60, 1
    s_nop 0
    v_mfma_f32_32x32x16_bf16 v[40:55], v[116:119], v[124:127], v[40:55]
    s_cbranch_scc1 L_atfin
    s_cmp_gt_i32 s64, 0
    s_cbranch_scc1 L_yf
L_yfb:
    v_exp_f32 v56, v56
    v_exp_f32 v57, v57
    v_exp_f32 v58, v58
    v_exp_f32 v59, v59
    s_waitcnt lgkmcnt(4)
    v_mfma_f32_32x32x16_bf16 v[72:87], v[96:99], v[144:147], 0
    v_exp_f32 v60, v60
    v_exp_f32 v61, v61
    v_exp_f32 v62, v62
    v_exp_f32 v63, v63
    v_mfma_f32_32x32x16_bf16 v[72:87], v[100:103], v[148:151], v[72:87]
    ds_read_b128 v[88:91], v160 offset:2048
    ds_read_b128 v[92:95], v161 offset:2048
    v_cvt_pk_bf16_f32 v120, v56, v57
    v_cvt_pk_bf16_f32 v121, v58, v59
    v_cvt_pk_bf16_f32 v122, v60, v61
    v_cvt_pk_bf16_f32 v123, v62, v63
    v_exp_f32 v64, v64
    v_exp_f32 v65, v65
    s_waitcnt lgkmcnt(2)
    v_mfma_f32_32x32x16_bf16 v[40:55], v[104:107], v[120:123], v[40:55]
    ds_read_b64_tr_b16 v[112:113], v162 offset:2560
    ds_read_b64_tr_b16 v[114:115], v162 offset:2688
    ds_read_b64_tr_b16 v[116:117], v162 offset:2816
    ds_read_b64_tr_b16 v[118:119], v162 offset:2944
    v_exp_f32 v66, v66
    v_exp_f32 v67, v67
    v_exp_f32 v68, v68
    v_exp_f32 v69, v69
    v_exp_f32 v70, v70
    v_exp_f32 v71, v71
    v_cvt_pk_bf16_f32 v124, v64, v65
    v_cvt_pk_bf16_f32 v125, v66, v67
    v_cvt_pk_bf16_f32 v126, v68, v69
    v_cvt_pk_bf16_f32 v127, v70, v71
    s_cmp_eq_u32 s60, 2
    s_nop 0
    v_mfma_f32_32x32x16_bf16 v[40:55], v[108:111], v[124:127], v[40:55]
    s_cbranch_scc1 L_atfin
    v_exp_f32 v72, v72
    v_exp_f32 v73, v73
    v_exp_f32 v74, v74
    v_exp_f32 v75, v75
    s_waitcnt lgkmcnt(4)
    v_mfma_f32_32x32x16_bf16 v[56:71], v[88:91], v[144:147], 0
    v_exp_f32 v76, v76
    v_exp_f32 v77, v77
    v_exp_f32 v78, v78
    v_exp_f32 v79, v79
    v_mfma_f32_32x32x16_bf16 v[56:71], v[92:95], v[148:151], v[56:71]
    ds_read_b128 v[96:99], v160 offset:1536
    ds_read_b128 v[100:103], v161 offset:1536
    v_cvt_pk_bf16_f32 v120, v72, v73
    v_cvt_pk_bf16_f32 v121, v74, v75
    v_cvt_pk_bf16_f32 v122, v76, v77
    v_cvt_pk_bf16_f32 v123, v78, v79
    v_exp_f32 v80, v80
    v_exp_f32 v81, v81
    s_waitcnt lgkmcnt(2)
    v_mfma_f32_32x32x16_bf16 v[40:55], v[112:115], v[120:123], v[40:55]
    ds_read_b64_tr_b16 v[104:105], v162 offset:2048
    ds_read_b64_tr_b16 v[106:107], v162 offset:2176
    ds_read_b64_tr_b16 v[108:109], v162 offset:2304
    ds_read_b64_tr_b16 v[110:111], v162 offset:2432
    v_exp_f32 v82, v82
    v_exp_f32 v83, v83
    v_exp_f32 v84, v84
    v_exp_f32 v85, v85
    v_exp_f32 v86, v86
    v_exp_f32 v87, v87
    v_cvt_pk_bf16_f32 v124, v80, v81
    v_cvt_pk_bf16_f32 v125, v82, v83
    v_cvt_pk_bf16_f32 v126, v84, v85
    v_cvt_pk_bf16_f32 v127, v86, v87
    s_cmp_eq_u32 s60, 3
    s_nop 0
    v_mfma_f32_32x32x16_bf16 v[40:55], v[116:119], v[124:127], v[40:55]
    s_cbranch_scc1 L_atfin
    v_exp_f32 v56, v56
    v_exp_f32 v57, v57
    v_exp_f32 v58, v58
    v_exp_f32 v59, v59
    s_waitcnt lgkmcnt(4)
    v_mfma_f32_32x32x16_bf16 v[72:87], v[96:99], v[144:147], 0
    v_exp_f32 v60, v60
    v_exp_f32 v61, v61
    v_exp_f32 v62, v62
    v_exp_f32 v63, v63
    v_mfma_f32_32x32x16_bf16 v[72:87], v[100:103], v[148:151], v[72:87]
    ds_read_b128 v[88:91], v160 offset:1024
    ds_read_b128 v[92:95], v161 offset:1024
    v_cvt_pk_bf16_f32 v120, v56, v57
    v_cvt_pk_bf16_f32 v121, v58, v59
    v_cvt_pk_bf16_f32 v122, v60, v61
    v_cvt_pk_bf16_f32 v123, v62, v63
    v_exp_f32 v64, v64
    v_exp_f32 v65, v65
    s_waitcnt lgkmcnt(2)
    v_mfma_f32_32x32x16_bf16 v[40:55], v[104:107], v[120:123], v[40:55]
    ds_read_b64_tr_b16 v[112:113], v162 offset:1536
    ds_read_b64_tr_b16 v[114:115], v162 offset:1664
    ds_read_b64_tr_b16 v[116:117], v162 offset:1792
    ds_read_b64_tr_b16 v[118:119], v162 offset:1920
    v_exp_f32 v66, v66
    v_exp_f32 v67, v67
    v_exp_f32 v68, v68
    v_exp_f32 v69, v69
    v_exp_f32 v70, v70
    v_exp_f32 v71, v71
    v_cvt_pk_bf16_f32 v124, v64, v65
    v_cvt_pk_bf16_f32 v125, v66, v67
    v_cvt_pk_bf16_f32 v126, v68, v69
    v_cvt_pk_bf16_f32 v127, v70, v71
    s_cmp_eq_u32 s60, 4
    s_nop 0
    v_mfma_f32_32x32x16_bf16 v[40:55], v[108:111], v[124:127], v[40:55]
    s_cbranch_scc1 L_atfin
    v_exp_f32 v72, v72
    v_exp_f32 v73, v73
    v_exp_f32 v74, v74
    v_exp_f32 v75, v75
    s_waitcnt lgkmcnt(4)
    v_mfma_f32_32x32x16_bf16 v[56:71], v[88:91], v[144:147], 0
    v_exp_f32 v76, v76
    v_exp_f32 v77, v77
    v_exp_f32 v78, v78
    v_exp_f32 v79, v79
    v_mfma_f32_32x32x16_bf16 v[56:71], v[92:95], v[148:151], v[56:71]
    ds_read_b128 v[96:99], v160 offset:512
    ds_read_b128 v[100:103], v161 offset:512
    v_cvt_pk_bf16_f32 v120, v72, v73
    v_cvt_pk_bf16_f32 v121, v74, v75
    v_cvt_pk_bf16_f32 v122, v76, v77
    v_cvt_pk_bf16_f32 v123, v78, v79
    v_exp_f32 v80, v80
    v_exp_f32 v81, v81
    s_waitcnt lgkmcnt(2)
    v_mfma_f32_32x32x16_bf16 v[40:55], v[112:115], v[120:123], v[40:55]
    ds_read_b64_tr_b16 v[104:105], v162 offset:1024
    ds_read_b64_tr_b16 v[106:107], v162 offset:1152
    ds_read_b64_tr_b16 v[108:109], v162 offset:1280
    ds_read_b64_tr_b16 v[110:111], v162 offset:1408
    v_exp_f32 v82, v82
    v_exp_f32 v83, v83
    v_exp_f32 v84, v84
    v_exp_f32 v85, v85
    v_exp_f32 v86, v86
    v_exp_f32 v87, v87
    v_cvt_pk_bf16_f32 v124, v80, v81
    v_cvt_pk_bf16_f32 v125, v82, v83
    v_cvt_pk_bf16_f32 v126, v84, v85
    v_cvt_pk_bf16_f32 v127, v86, v87
    s_cmp_eq_u32 s60, 5
    s_nop 0
    v_mfma_f32_32x32x16_bf16 v[40:55], v[116:119], v[124:127], v[40:55]
    s_cbranch_scc1 L_atfin
    v_exp_f32 v56, v56
    v_exp_f32 v57, v57
    v_exp_f32 v58, v58
    v_exp_f32 v59, v59
    s_waitcnt lgkmcnt(4)
    v_mfma_f32_32x32x16_bf16 v[72:87], v[96:99], v[144:147], 0
    v_exp_f32 v60, v60
    v_exp_f32 v61, v61
    v_exp_f32 v62, v62
    v_exp_f32 v63, v63
    v_mfma_f32_32x32x16_bf16 v[72:87], v[100:103], v[148:151], v[72:87]
    ds_read_b128 v[88:91], v160 offset:0
    ds_read_b128 v[92:95], v161 offset:0
    v_cvt_pk_bf16_f32 v120, v56, v57
    v_cvt_pk_bf16_f32 v121, v58, v59
    v_cvt_pk_bf16_f32 v122, v60, v61
    v_cvt_pk_bf16_f32 v123, v62, v63
    v_exp_f32 v64, v64
    v_exp_f32 v65, v65
    s_waitcnt lgkmcnt(2)
    v_mfma_f32_32x32x16_bf16 v[40:55], v[104:107], v[120:123], v[40:55]
    ds_read_b64_tr_b16 v[112:113], v162 offset:512
    ds_read_b64_tr_b16 v[114:115], v162 offset:640
    ds_read_b64_tr_b16 v[116:117], v162 offset:768
    ds_read_b64_tr_b16 v[118:119], v162 offset:896
    v_exp_f32 v66, v66
    v_exp_f32 v67, v67
    v_exp_f32 v68, v68
    v_exp_f32 v69, v69
    v_exp_f32 v70, v70
    v_exp_f32 v71, v71
    v_cvt_pk_bf16_f32 v124, v64, v65
    v_cvt_pk_bf16_f32 v125, v66, v67
    v_cvt_pk_bf16_f32 v126, v68, v69
    v_cvt_pk_bf16_f32 v127, v70, v71
    s_cmp_eq_u32 s60, 6
    s_nop 0
    v_mfma_f32_32x32x16_bf16 v[40:55], v[108:111], v[124:127], v[40:55]
    s_cbranch_scc1 L_atfin
    v_exp_f32 v72, v72
    v_exp_f32 v73, v73
    v_exp_f32 v74, v74
    v_exp_f32 v75, v75
    s_waitcnt lgkmcnt(4)
    v_mfma_f32_32x32x16_bf16 v[56:71], v[88:91], v[144:147], 0
    v_exp_f32 v76, v76
    v_exp_f32 v77, v77
    v_exp_f32 v78, v78
    v_exp_f32 v79, v79
    v_mfma_f32_32x32x16_bf16 v[56:71], v[92:95], v[148:151], v[56:71]
    v_cvt_pk_bf16_f32 v120, v72, v73
    v_cvt_pk_bf16_f32 v121, v74, v75
    v_cvt_pk_bf16_f32 v122, v76, v77
    v_cvt_pk_bf16_f32 v123, v78, v79
    v_exp_f32 v80, v80
    v_exp_f32 v81, v81
    s_waitcnt lgkmcnt(0)
    v_mfma_f32_32x32x16_bf16 v[40:55], v[112:115], v[120:123], v[40:55]
    ds_read_b64_tr_b16 v[104:105], v162 offset:0
    ds_read_b64_tr_b16 v[106:107], v162 offset:128
    ds_read_b64_tr_b16 v[108:109], v162 offset:256
    ds_read_b64_tr_b16 v[110:111], v162 offset:384
    v_exp_f32 v82, v82
    v_exp_f32 v83, v83
    v_exp_f32 v84, v84
    v_exp_f32 v85, v85
    v_exp_f32 v86, v86
    v_exp_f32 v87, v87
    v_cvt_pk_bf16_f32 v124, v80, v81
    v_cvt_pk_bf16_f32 v125, v82, v83
    v_cvt_pk_bf16_f32 v126, v84, v85
    v_cvt_pk_bf16_f32 v127, v86, v87
    s_cmp_eq_u32 s60, 7
    s_nop 0
    v_mfma_f32_32x32x16_bf16 v[40:55], v[116:119], v[124:127], v[40:55]
    s_cbranch_scc1 L_atfin
    v_exp_f32 v56, v56
    v_exp_f32 v57, v57
    v_exp_f32 v58, v58
    v_exp_f32 v59, v59
    v_exp_f32 v60, v60
    v_exp_f32 v61, v61
    v_exp_f32 v62, v62
    v_exp_f32 v63, v63
    v_cvt_pk_bf16_f32 v120, v56, v57
    v_cvt_pk_bf16_f32 v121, v58, v59
    v_cvt_pk_bf16_f32 v122, v60, v61
    v_cvt_pk_bf16_f32 v123, v62, v63
    v_bfi_b32 v120, v152, 0, v120
    v_bfi_b32 v121, v153, 0, v121
    v_bfi_b32 v122, v154, 0, v122
    v_bfi_b32 v123, v155, 0, v123
    v_exp_f32 v64, v64
    v_exp_f32 v65, v65
    s_waitcnt lgkmcnt(0)
    v_mfma_f32_32x32x16_bf16 v[40:55], v[104:107], v[120:123], v[40:55]
    v_exp_f32 v66, v66
    v_exp_f32 v67, v67
    v_exp_f32 v68, v68
    v_exp_f32 v69, v69
    v_exp_f32 v70, v70
    v_exp_f32 v71, v71
    v_cvt_pk_bf16_f32 v124, v64, v65
    v_cvt_pk_bf16_f32 v125, v66, v67
    v_cvt_pk_bf16_f32 v126, v68, v69
    v_cvt_pk_bf16_f32 v127, v70, v71
    v_bfi_b32 v124, v156, 0, v124
    v_bfi_b32 v125, v157, 0, v125
    v_bfi_b32 v126, v158, 0, v126
    v_bfi_b32 v127, v159, 0, v127
    s_nop 1
    v_mfma_f32_32x32x16_bf16 v[40:55], v[108:111], v[124:127], v[40:55]
L_atfin:
    v_bfe_u32 v8, v166, 2, 7
    s_waitcnt lgkmcnt(0)
    s_nop 8
    s_nop 0
    v_rcp_f32 v56, v52
    v_pk_mul_f32 v[72:73], v[40:41], 0
    v_pk_fma_f32 v[72:73], v[42:43], 0, v[72:73]
    v_pk_fma_f32 v[72:73], v[44:45], 0, v[72:73]
    v_pk_fma_f32 v[72:73], v[46:47], 0, v[72:73]
    v_pk_fma_f32 v[72:73], v[48:49], 0, v[72:73]
    v_pk_fma_f32 v[72:73], v[50:51], 0, v[72:73]
    v_mov_b32 v57, v56
    v_add_f32 v72, v72, v73
    v_add_f32 v72, v72, v52
    v_cmp_nge_f32 vcc, 0x4e800000, v72
    s_nop 0
    s_cbranch_vccnz L_atfb
    v_cmp_gt_f32 vcc, 0x30800000, v52
    s_nop 0
    s_cbranch_vccnz L_atfb
L_atout:
    v_pk_mul_f32 v[40:41], v[40:41], v[56:57]
    v_pk_mul_f32 v[42:43], v[42:43], v[56:57]
    v_pk_mul_f32 v[44:45], v[44:45], v[56:57]
    v_pk_mul_f32 v[46:47], v[46:47], v[56:57]
    v_pk_mul_f32 v[48:49], v[48:49], v[56:57]
    v_pk_mul_f32 v[50:51], v[50:51], v[56:57]
    v_cvt_pk_bf16_f32 v144, v40, v41
    v_cvt_pk_bf16_f32 v145, v42, v43
    v_cvt_pk_bf16_f32 v146, v44, v45
    v_cvt_pk_bf16_f32 v147, v46, v47
    v_cvt_pk_bf16_f32 v148, v48, v49
    buffer_store_dwordx4 v[144:147], v166, s[28:31], s65 offen sc1
    s_cmp_eq_u32 s68, 0
    s_cbranch_scc1 L_atev
    v_cvt_pk_bf16_f32 v148, v50, v51
L_atev:
    s_mov_b32 exec_hi, 0
    buffer_store_dword v148, v8, s[28:31], s66 offen sc1
    s_mov_b64 exec, -1
    s_setprio 0
    v_mov_b32 v9, 1
    ds_write_b32 v10, v9 offset:64
    s_mov_b32 s36, s22
    s_mov_b32 s37, s23
    s_mov_b32 s38, 4718592
    s_mov_b32 s39, 0x20000
    s_mov_b32 s47, s87
    v_lshrrev_b32 v12, 4, v2
    v_and_b32 v13, 15, v2
    v_lshlrev_b32 v14, 15, v12
    v_lshl_add_u32 v15, v13, 2, v14
    v_lshl_add_u32 v14, v13, 4, v14
    s_and_b32 s48, s44, 2
    s_add_u32 s48, s48, s47
    s_lshl_b32 s48, s48, 1
    s_add_u32 s48, s48, 157312
    v_mov_b32 v16, s48
    v_bfe_u32 v8, v2, 2, 2
    v_and_b32 v9, 3, v2
    v_lshlrev_b32 v9, 3, v9
    s_mul_i32 s49, s47, 95616
    s_add_u32 s49, s49, 0
    v_add_u32 v9, s49, v9
    s_movk_i32 s50, 160
    v_lshrrev_b32 v18, 1, v12
    v_mul_u32_u24 v18, 20, v18
    v_and_b32 v19, 1, v12
    v_lshl_add_u32 v18, v19, 2, v18
    v_add_u32 v18, v18, v8
    v_mad_u32_u24 v18, v18, s50, v9
    v_mul_u32_u24 v19, 72, v12
    v_add_u32 v19, v19, v8
    v_mad_u32_u24 v19, v19, s50, v9
    v_and_b32 v8, 1, v2
    v_lshl_add_u32 v8, s47, 1, v8
    v_lshlrev_b32 v8, 2, v8
    v_add_u32 v8, 157220, v8
    s_add_u32 s51, s86, 8192
    s_add_u32 s52, s86, 16384
    s_add_u32 s53, s86, 24576
    s_waitcnt vmcnt(0)
    v_mov_b32 v6, s67
    v_mov_b32 v7, s45
    s_mov_b64 exec, 1
    buffer_store_dword v7, v6, s[28:31], 0 offen sc1
    s_mov_b64 exec, -1
    v_mov_b32 v4, s64
    v_mov_b32 v5, s45
    s_mov_b64 exec, 1
    buffer_store_dword v5, v4, s[28:31], 0 offen sc1
    s_mov_b64 exec, -1
    s_mov_b32 s59, 1048576
    s_mov_b32 s54, 0
    s_and_b32 s55, s93, 7
    s_lshl_b32 s58, s55, 17
    s_add_u32 s71, s58, s70
    s_mul_i32 s78, s55, 5760
    s_add_u32 s55, s55, 1
    s_and_b32 s55, s55, 7
    s_lshl_b32 s58, s55, 17
    s_add_u32 s72, s58, s70
    s_mul_i32 s79, s55, 5760
    s_add_u32 s55, s55, 1
    s_and_b32 s55, s55, 7
    s_lshl_b32 s58, s55, 17
    s_add_u32 s73, s58, s70
    s_mul_i32 s80, s55, 5760
    s_add_u32 s55, s55, 1
    s_and_b32 s55, s55, 7
    s_lshl_b32 s58, s55, 17
    s_add_u32 s74, s58, s70
    s_mul_i32 s81, s55, 5760
    s_add_u32 s55, s55, 1
    s_and_b32 s55, s55, 7
    s_lshl_b32 s58, s55, 17
    s_add_u32 s75, s58, s70
    s_mul_i32 s82, s55, 5760
    s_add_u32 s55, s55, 1
    s_and_b32 s55, s55, 7
    s_lshl_b32 s58, s55, 17
    s_add_u32 s76, s58, s70
    s_mul_i32 s83, s55, 5760
    s_add_u32 s55, s55, 1
    s_and_b32 s55, s55, 7
    s_lshl_b32 s58, s55, 17
    s_add_u32 s77, s58, s70
    s_mul_i32 s84, s55, 5760
    s_add_u32 s55, s55, 1
    s_and_b32 s55, s55, 7
    s_lshl_b32 s58, s55, 17
    s_add_u32 s57, s58, s70
    s_mul_i32 s85, s55, 5760
    s_add_u32 s55, s55, 1
    s_and_b32 s55, s55, 7
    s_mov_b32 s59, 262144
L_wogp:
    ds_read_b32 v9, v8 offset:0
    s_waitcnt lgkmcnt(0)
    v_cmp_eq_u32 vcc, 0, v9
    s_nop 0
    s_cbranch_vccz L_wogd
    s_sleep 1
    s_sub_u32 s59, s59, 1
    s_cmp_lg_u32 s59, 0
    s_cbranch_scc1 L_wogp
L_wogd:
    s_mov_b32 s59, 1048576
    v_add_u32 v8, s78, v18
    ds_read_b64_tr_b16 v[68:69], v8 offset:0
    ds_read_b64_tr_b16 v[70:71], v8 offset:1280
    ds_read_b64_tr_b16 v[72:73], v8 offset:32
    ds_read_b64_tr_b16 v[74:75], v8 offset:1312
    ds_read_b64_tr_b16 v[76:77], v8 offset:64
    ds_read_b64_tr_b16 v[78:79], v8 offset:1344
    ds_read_b64_tr_b16 v[80:81], v8 offset:96
    ds_read_b64_tr_b16 v[82:83], v8 offset:1376
    ds_read_b64_tr_b16 v[84:85], v8 offset:128
    ds_read_b64_tr_b16 v[86:87], v8 offset:1408
    v_add_u32 v8, s79, v18
    ds_read_b64_tr_b16 v[88:89], v8 offset:0
    ds_read_b64_tr_b16 v[90:91], v8 offset:1280
    ds_read_b64_tr_b16 v[92:93], v8 offset:32
    ds_read_b64_tr_b16 v[94:95], v8 offset:1312
    ds_read_b64_tr_b16 v[96:97], v8 offset:64
    ds_read_b64_tr_b16 v[98:99], v8 offset:1344
    ds_read_b64_tr_b16 v[100:101], v8 offset:96
    ds_read_b64_tr_b16 v[102:103], v8 offset:1376
    ds_read_b64_tr_b16 v[104:105], v8 offset:128
    ds_read_b64_tr_b16 v[106:107], v8 offset:1408
    v_add_u32 v8, s80, v18
    ds_read_b64_tr_b16 v[108:109], v8 offset:0
    ds_read_b64_tr_b16 v[110:111], v8 offset:1280
    ds_read_b64_tr_b16 v[112:113], v8 offset:32
    ds_read_b64_tr_b16 v[114:115], v8 offset:1312
    ds_read_b64_tr_b16 v[116:117], v8 offset:64
    ds_read_b64_tr_b16 v[118:119], v8 offset:1344
    ds_read_b64_tr_b16 v[120:121], v8 offset:96
    ds_read_b64_tr_b16 v[122:123], v8 offset:1376
    ds_read_b64_tr_b16 v[124:125], v8 offset:128
    ds_read_b64_tr_b16 v[126:127], v8 offset:1408
    v_add_u32 v8, s81, v18
    ds_read_b64_tr_b16 v[128:129], v8 offset:0
    ds_read_b64_tr_b16 v[130:131], v8 offset:1280
    ds_read_b64_tr_b16 v[132:133], v8 offset:32
    ds_read_b64_tr_b16 v[134:135], v8 offset:1312
    ds_read_b64_tr_b16 v[136:137], v8 offset:64
    ds_read_b64_tr_b16 v[138:139], v8 offset:1344
    ds_read_b64_tr_b16 v[140:141], v8 offset:96
    ds_read_b64_tr_b16 v[142:143], v8 offset:1376
    ds_read_b64_tr_b16 v[144:145], v8 offset:128
    ds_read_b64_tr_b16 v[146:147], v8 offset:1408
    v_add_u32 v8, s82, v18
    ds_read_b64_tr_b16 v[148:149], v8 offset:0
    ds_read_b64_tr_b16 v[150:151], v8 offset:1280
    ds_read_b64_tr_b16 v[152:153], v8 offset:32
    ds_read_b64_tr_b16 v[154:155], v8 offset:1312
    ds_read_b64_tr_b16 v[156:157], v8 offset:64
    ds_read_b64_tr_b16 v[158:159], v8 offset:1344
    ds_read_b64_tr_b16 v[160:161], v8 offset:96
    ds_read_b64_tr_b16 v[162:163], v8 offset:1376
    ds_read_b64_tr_b16 v[164:165], v8 offset:128
    ds_read_b64_tr_b16 v[166:167], v8 offset:1408
    s_bitcmp1_b32 s54, 0
    s_cbranch_scc0 L_op0
L_og0:
    buffer_load_dwordx4 v[20:23], v14, s[28:31], s71 offen sc1
    s_bitcmp1_b32 s54, 2
    s_cbranch_scc0 L_op1
L_og1:
    buffer_load_dwordx4 v[24:27], v14, s[28:31], s72 offen sc1
    s_bitcmp1_b32 s54, 4
    s_cbranch_scc0 L_op2
L_og2:
    buffer_load_dwordx4 v[28:31], v14, s[28:31], s73 offen sc1
    s_bitcmp1_b32 s54, 6
    s_cbranch_scc0 L_op3
L_og3:
    buffer_load_dwordx4 v[32:35], v14, s[28:31], s74 offen sc1
    s_bitcmp1_b32 s54, 8
    s_cbranch_scc0 L_op4
L_og4:
    buffer_load_dwordx4 v[36:39], v14, s[28:31], s75 offen sc1
    s_bitcmp1_b32 s54, 10
    s_cbranch_scc0 L_op5
L_og5:
    buffer_load_dwordx4 v[40:43], v14, s[28:31], s76 offen sc1
    s_waitcnt vmcnt(5) lgkmcnt(0)
    v_mfma_f32_16x16x32_bf16 v[48:51], v[68:71], v[20:23], 0
    v_mfma_f32_16x16x32_bf16 v[52:55], v[72:75], v[20:23], 0
    v_mfma_f32_16x16x32_bf16 v[56:59], v[76:79], v[20:23], 0
    v_mfma_f32_16x16x32_bf16 v[60:63], v[80:83], v[20:23], 0
    v_mfma_f32_16x16x32_bf16 v[64:67], v[84:87], v[20:23], 0
    v_add_u32 v8, s83, v18
    ds_read_b64_tr_b16 v[68:69], v8 offset:0
    ds_read_b64_tr_b16 v[70:71], v8 offset:1280
    ds_read_b64_tr_b16 v[72:73], v8 offset:32
    ds_read_b64_tr_b16 v[74:75], v8 offset:1312
    ds_read_b64_tr_b16 v[76:77], v8 offset:64
    ds_read_b64_tr_b16 v[78:79], v8 offset:1344
    ds_read_b64_tr_b16 v[80:81], v8 offset:96
    ds_read_b64_tr_b16 v[82:83], v8 offset:1376
    ds_read_b64_tr_b16 v[84:85], v8 offset:128
    ds_read_b64_tr_b16 v[86:87], v8 offset:1408
    s_bitcmp1_b32 s54, 12
    s_cbranch_scc0 L_op6
L_og6:
    buffer_load_dwordx4 v[20:23], v14, s[28:31], s77 offen sc1
    s_waitcnt vmcnt(5) lgkmcnt(15)
    v_mfma_f32_16x16x32_bf16 v[48:51], v[88:91], v[24:27], v[48:51]
    v_mfma_f32_16x16x32_bf16 v[52:55], v[92:95], v[24:27], v[52:55]
    v_mfma_f32_16x16x32_bf16 v[56:59], v[96:99], v[24:27], v[56:59]
    v_mfma_f32_16x16x32_bf16 v[60:63], v[100:103], v[24:27], v[60:63]
    v_mfma_f32_16x16x32_bf16 v[64:67], v[104:107], v[24:27], v[64:67]
    v_add_u32 v8, s84, v18
    ds_read_b64_tr_b16 v[88:89], v8 offset:0
    ds_read_b64_tr_b16 v[90:91], v8 offset:1280
    ds_read_b64_tr_b16 v[92:93], v8 offset:32
    ds_read_b64_tr_b16 v[94:95], v8 offset:1312
    ds_read_b64_tr_b16 v[96:97], v8 offset:64
    ds_read_b64_tr_b16 v[98:99], v8 offset:1344
    ds_read_b64_tr_b16 v[100:101], v8 offset:96
    ds_read_b64_tr_b16 v[102:103], v8 offset:1376
    ds_read_b64_tr_b16 v[104:105], v8 offset:128
    ds_read_b64_tr_b16 v[106:107], v8 offset:1408
    s_bitcmp1_b32 s54, 14
    s_cbranch_scc0 L_op7
L_og7:
    buffer_load_dwordx4 v[24:27], v14, s[28:31], s57 offen sc1
    buffer_load_dword v44, v15, s[28:31], s86 offen sc1
    buffer_load_dword v45, v15, s[28:31], s51 offen sc1
    buffer_load_dword v46, v15, s[28:31], s52 offen sc1
    buffer_load_dword v47, v15, s[28:31], s53 offen sc1
    s_waitcnt vmcnt(9) lgkmcnt(15)
    v_mfma_f32_16x16x32_bf16 v[48:51], v[108:111], v[28:31], v[48:51]
    v_mfma_f32_16x16x32_bf16 v[52:55], v[112:115], v[28:31], v[52:55]
    v_mfma_f32_16x16x32_bf16 v[56:59], v[116:119], v[28:31], v[56:59]
    v_mfma_f32_16x16x32_bf16 v[60:63], v[120:123], v[28:31], v[60:63]
    v_mfma_f32_16x16x32_bf16 v[64:67], v[124:127], v[28:31], v[64:67]
    v_add_u32 v8, s85, v18
    ds_read_b64_tr_b16 v[108:109], v8 offset:0
    ds_read_b64_tr_b16 v[110:111], v8 offset:1280
    ds_read_b64_tr_b16 v[112:113], v8 offset:32
    ds_read_b64_tr_b16 v[114:115], v8 offset:1312
    ds_read_b64_tr_b16 v[116:117], v8 offset:64
    ds_read_b64_tr_b16 v[118:119], v8 offset:1344
    ds_read_b64_tr_b16 v[120:121], v8 offset:96
    ds_read_b64_tr_b16 v[122:123], v8 offset:1376
    ds_read_b64_tr_b16 v[124:125], v8 offset:128
    ds_read_b64_tr_b16 v[126:127], v8 offset:1408
    s_waitcnt vmcnt(8) lgkmcnt(15)
    v_mfma_f32_16x16x32_bf16 v[48:51], v[128:131], v[32:35], v[48:51]
    v_mfma_f32_16x16x32_bf16 v[52:55], v[132:135], v[32:35], v[52:55]
    v_mfma_f32_16x16x32_bf16 v[56:59], v[136:139], v[32:35], v[56:59]
    v_mfma_f32_16x16x32_bf16 v[60:63], v[140:143], v[32:35], v[60:63]
    v_mfma_f32_16x16x32_bf16 v[64:67], v[144:147], v[32:35], v[64:67]
    ds_read_b64_tr_b16 v[128:129], v19 offset:2560
    ds_read_b64_tr_b16 v[130:131], v19 offset:8320
    ds_read_b64_tr_b16 v[132:133], v19 offset:2592
    ds_read_b64_tr_b16 v[134:135], v19 offset:8352
    ds_read_b64_tr_b16 v[136:137], v19 offset:2624
    ds_read_b64_tr_b16 v[138:139], v19 offset:8384
    ds_read_b64_tr_b16 v[140:141], v19 offset:2656
    ds_read_b64_tr_b16 v[142:143], v19 offset:8416
    ds_read_b64_tr_b16 v[144:145], v19 offset:2688
    ds_read_b64_tr_b16 v[146:147], v19 offset:8448
    s_waitcnt vmcnt(7) lgkmcnt(15)
    v_mfma_f32_16x16x32_bf16 v[48:51], v[148:151], v[36:39], v[48:51]
    v_mfma_f32_16x16x32_bf16 v[52:55], v[152:155], v[36:39], v[52:55]
    v_mfma_f32_16x16x32_bf16 v[56:59], v[156:159], v[36:39], v[56:59]
    v_mfma_f32_16x16x32_bf16 v[60:63], v[160:163], v[36:39], v[60:63]
    v_mfma_f32_16x16x32_bf16 v[64:67], v[164:167], v[36:39], v[64:67]
    s_waitcnt vmcnt(6) lgkmcnt(15)
    v_mfma_f32_16x16x32_bf16 v[48:51], v[68:71], v[40:43], v[48:51]
    v_mfma_f32_16x16x32_bf16 v[52:55], v[72:75], v[40:43], v[52:55]
    v_mfma_f32_16x16x32_bf16 v[56:59], v[76:79], v[40:43], v[56:59]
    v_mfma_f32_16x16x32_bf16 v[60:63], v[80:83], v[40:43], v[60:63]
    v_mfma_f32_16x16x32_bf16 v[64:67], v[84:87], v[40:43], v[64:67]
    s_waitcnt vmcnt(5) lgkmcnt(15)
    v_mfma_f32_16x16x32_bf16 v[48:51], v[88:91], v[20:23], v[48:51]
    v_mfma_f32_16x16x32_bf16 v[52:55], v[92:95], v[20:23], v[52:55]
    v_mfma_f32_16x16x32_bf16 v[56:59], v[96:99], v[20:23], v[56:59]
    v_mfma_f32_16x16x32_bf16 v[60:63], v[100:103], v[20:23], v[60:63]
    v_mfma_f32_16x16x32_bf16 v[64:67], v[104:107], v[20:23], v[64:67]
    s_waitcnt vmcnt(4) lgkmcnt(10)
    v_mfma_f32_16x16x32_bf16 v[48:51], v[108:111], v[24:27], v[48:51]
    v_mfma_f32_16x16x32_bf16 v[52:55], v[112:115], v[24:27], v[52:55]
    v_mfma_f32_16x16x32_bf16 v[56:59], v[116:119], v[24:27], v[56:59]
    v_mfma_f32_16x16x32_bf16 v[60:63], v[120:123], v[24:27], v[60:63]
    v_mfma_f32_16x16x32_bf16 v[64:67], v[124:127], v[24:27], v[64:67]
    s_waitcnt vmcnt(0) lgkmcnt(0)
    v_mfma_f32_16x16x32_bf16 v[48:51], v[128:131], v[44:47], v[48:51]
    v_mfma_f32_16x16x32_bf16 v[52:55], v[132:135], v[44:47], v[52:55]
    v_mfma_f32_16x16x32_bf16 v[56:59], v[136:139], v[44:47], v[56:59]
    v_mfma_f32_16x16x32_bf16 v[60:63], v[140:143], v[44:47], v[60:63]
    v_mfma_f32_16x16x32_bf16 v[64:67], v[144:147], v[44:47], v[64:67]
    v_and_b32 v8, 7, v2
    v_lshlrev_b32 v8, 2, v8
    v_add_u32 v8, 157248, v8
    s_mov_b32 s59, 262144
L_kvdp:
    ds_read_b32 v9, v8 offset:0
    s_waitcnt lgkmcnt(0)
    v_cmp_eq_u32 vcc, 0, v9
    s_nop 0
    s_cbranch_vccz L_kvdd
    s_sub_u32 s59, s59, 1
    s_cmp_lg_u32 s59, 0
    s_cbranch_scc1 L_kvdp
L_kvdd:
    s_and_b32 s46, s44, 3
    s_mul_i32 s49, s46, 5120
    s_add_u32 s49, s49, 46080
    v_lshlrev_b32 v18, 4, v2
    v_add_u32 v18, s49, v18
    v_add_u32 v8, 96, v10
    v_xor_b32 v9, 16, v8
    v_mov_b32 v19, 1
    s_cmp_lg_u32 s47, 0
    s_cbranch_scc1 L_a3k1
    ds_write_b128 v18, v[56:59] offset:2048
    ds_write_b128 v18, v[60:63] offset:3072
    s_lshl_b32 s48, s91, 4
    v_add_u32 v13, s48, v13
    v_mul_u32_u24 v13, 2304, v13
    v_and_b32 v15, 1, v12
    v_lshl_add_u32 v13, v15, 5, v13
    v_lshrrev_b32 v15, 1, v12
    v_lshl_add_u32 v13, v15, 4, v13
    s_and_b32 s48, s93, 7
    s_mul_i32 s48, s48, 144
    s_waitcnt lgkmcnt(0)
    ds_write_b32 v8, v19
    s_mov_b32 s59, 262144
L_a3w0p:
    ds_read_b32 v19, v9 offset:0
    s_waitcnt lgkmcnt(0)
    v_cmp_eq_u32 vcc, 0, v19
    s_nop 0
    s_cbranch_vccz L_a3w0d
    s_sub_u32 s59, s59, 1
    s_cmp_lg_u32 s59, 0
    s_cbranch_scc1 L_a3w0p
L_a3w0d:
    ds_read_b128 v[68:71], v18 offset:0
    ds_read_b128 v[72:75], v18 offset:1024
    ds_read_b128 v[84:87], v18 offset:4096
    s_waitcnt lgkmcnt(0)
    v_pk_add_f32 v[48:49], v[48:49], v[68:69]
    v_pk_add_f32 v[50:51], v[50:51], v[70:71]
    v_pk_add_f32 v[52:53], v[52:53], v[72:73]
    v_pk_add_f32 v[54:55], v[54:55], v[74:75]
    v_pk_add_f32 v[64:65], v[64:65], v[84:85]
    v_pk_add_f32 v[66:67], v[66:67], v[86:87]
    v_cvt_pk_bf16_f32 v20, v48, v49
    v_cvt_pk_bf16_f32 v21, v50, v51
    v_cvt_pk_bf16_f32 v22, v52, v53
    v_cvt_pk_bf16_f32 v23, v54, v55
    s_nop 0
    v_permlane16_swap_b32 v20, v22
    v_permlane16_swap_b32 v21, v23
    buffer_store_dwordx4 v[20:23], v13, s[36:39], s48 offen offset:0
    v_cvt_pk_bf16_f32 v28, v64, v65
    v_cvt_pk_bf16_f32 v29, v66, v67
    s_nop 0
    v_permlane16_swap_b32 v28, v30
    v_permlane16_swap_b32 v29, v31
    s_mov_b64 exec, 0xffff
    buffer_store_dwordx4 v[28:31], v13, s[36:39], s48 offen offset:128
    s_mov_b64 exec, -1
    s_branch L_fin
L_a3k1:
    ds_write_b128 v18, v[48:51] offset:0
    ds_write_b128 v18, v[52:55] offset:1024
    ds_write_b128 v18, v[64:67] offset:4096
    s_lshl_b32 s48, s91, 4
    v_add_u32 v13, s48, v13
    v_mul_u32_u24 v13, 2304, v13
    v_and_b32 v15, 1, v12
    v_lshl_add_u32 v13, v15, 5, v13
    v_lshrrev_b32 v15, 1, v12
    v_lshl_add_u32 v13, v15, 4, v13
    s_and_b32 s48, s93, 7
    s_mul_i32 s48, s48, 144
    s_waitcnt lgkmcnt(0)
    ds_write_b32 v8, v19
    s_mov_b32 s59, 262144
L_a3w1p:
    ds_read_b32 v19, v9 offset:0
    s_waitcnt lgkmcnt(0)
    v_cmp_eq_u32 vcc, 0, v19
    s_nop 0
    s_cbranch_vccz L_a3w1d
    s_sub_u32 s59, s59, 1
    s_cmp_lg_u32 s59, 0
    s_cbranch_scc1 L_a3w1p
L_a3w1d:
    ds_read_b128 v[76:79], v18 offset:2048
    ds_read_b128 v[80:83], v18 offset:3072
    s_waitcnt lgkmcnt(0)
    v_pk_add_f32 v[56:57], v[56:57], v[76:77]
    v_pk_add_f32 v[58:59], v[58:59], v[78:79]
    v_pk_add_f32 v[60:61], v[60:61], v[80:81]
    v_pk_add_f32 v[62:63], v[62:63], v[82:83]
    v_cvt_pk_bf16_f32 v24, v56, v57
    v_cvt_pk_bf16_f32 v25, v58, v59
    v_cvt_pk_bf16_f32 v26, v60, v61
    v_cvt_pk_bf16_f32 v27, v62, v63
    s_nop 0
    v_permlane16_swap_b32 v24, v26
    v_permlane16_swap_b32 v25, v27
    buffer_store_dwordx4 v[24:27], v13, s[36:39], s48 offen offset:64
L_fin:
L_end:
    s_endpgm
L_yf:
    s_waitcnt vmcnt(0)
    v_mov_b32 v6, s64
    v_mov_b32 v7, s45
    s_mov_b64 exec, 1
    buffer_store_dword v7, v6, s[28:31], 0 offen sc1
    s_mov_b64 exec, -1
    s_mov_b32 s64, 0x80000000
    s_branch L_yfb
L_atfb:
    s_cmp_lg_u32 s55, 0
    s_cbranch_scc1 L_atout
    s_mov_b32 s55, 1
    s_mov_b32 exec_lo, 0
    v_mov_b32 v148, 0
    v_mov_b32 v149, 0
    s_mov_b32 exec_lo, -1
    v_mov_b32 v11, v160
    v_mov_b32 v12, v161
    v_mov_b32 v16, 0xff800000
    v_mov_b32 v17, 0xff800000
    s_min_u32 s56, s60, 8
    s_mov_b32 s59, 0
L_atfbl:
    ds_read_b128 v[88:91], v11 offset:4096
    ds_read_b128 v[92:95], v12 offset:4096
    v_subrev_u32 v11, 0x200, v11
    v_subrev_u32 v12, 0x200, v12
    v_bfe_i32 v72, v152, 0, 1
    v_bfe_i32 v73, v152, 16, 1
    v_bfe_i32 v74, v153, 0, 1
    v_bfe_i32 v75, v153, 16, 1
    v_bfe_i32 v76, v154, 0, 1
    v_bfe_i32 v77, v154, 16, 1
    v_bfe_i32 v78, v155, 0, 1
    v_bfe_i32 v79, v155, 16, 1
    v_bfe_i32 v80, v156, 0, 1
    v_bfe_i32 v81, v156, 16, 1
    v_bfe_i32 v82, v157, 0, 1
    v_bfe_i32 v83, v157, 16, 1
    v_bfe_i32 v84, v158, 0, 1
    v_bfe_i32 v85, v158, 16, 1
    v_bfe_i32 v86, v159, 0, 1
    v_bfe_i32 v87, v159, 16, 1
    s_waitcnt lgkmcnt(0)
    v_mfma_f32_32x32x16_bf16 v[56:71], v[88:91], v[144:147], 0
    v_mfma_f32_32x32x16_bf16 v[56:71], v[92:95], v[148:151], v[56:71]
    s_nop 11
    s_cmp_lg_u32 s59, 0
    s_cbranch_scc1 L_fb1
    v_bfi_b32 v56, v72, v56, v17
    v_bfi_b32 v57, v73, v57, v17
    v_bfi_b32 v58, v74, v58, v17
    v_bfi_b32 v59, v75, v59, v17
    v_bfi_b32 v60, v76, v60, v17
    v_bfi_b32 v61, v77, v61, v17
    v_bfi_b32 v62, v78, v62, v17
    v_bfi_b32 v63, v79, v63, v17
    v_bfi_b32 v64, v80, v64, v17
    v_bfi_b32 v65, v81, v65, v17
    v_bfi_b32 v66, v82, v66, v17
    v_bfi_b32 v67, v83, v67, v17
    v_bfi_b32 v68, v84, v68, v17
    v_bfi_b32 v69, v85, v69, v17
    v_bfi_b32 v70, v86, v70, v17
    v_bfi_b32 v71, v87, v71, v17
L_fb1:
    s_cmp_lg_u32 s59, 8
    s_cbranch_scc1 L_fb2
    v_bfi_b32 v56, v72, v17, v56
    v_bfi_b32 v57, v73, v17, v57
    v_bfi_b32 v58, v74, v17, v58
    v_bfi_b32 v59, v75, v17, v59
    v_bfi_b32 v60, v76, v17, v60
    v_bfi_b32 v61, v77, v17, v61
    v_bfi_b32 v62, v78, v17, v62
    v_bfi_b32 v63, v79, v17, v63
    v_bfi_b32 v64, v80, v17, v64
    v_bfi_b32 v65, v81, v17, v65
    v_bfi_b32 v66, v82, v17, v66
    v_bfi_b32 v67, v83, v17, v67
    v_bfi_b32 v68, v84, v17, v68
    v_bfi_b32 v69, v85, v17, v69
    v_bfi_b32 v70, v86, v17, v70
    v_bfi_b32 v71, v87, v17, v71
L_fb2:
    v_max3_f32 v16, v16, v56, v57
    v_max3_f32 v16, v16, v58, v59
    v_max3_f32 v16, v16, v60, v61
    v_max3_f32 v16, v16, v62, v63
    v_max3_f32 v16, v16, v64, v65
    v_max3_f32 v16, v16, v66, v67
    v_max3_f32 v16, v16, v68, v69
    v_max3_f32 v16, v16, v70, v71
    s_add_u32 s59, s59, 1
    s_cmp_le_u32 s59, s56
    s_cbranch_scc1 L_atfbl
    v_mov_b32 v17, v16
    s_nop 1
    v_permlane32_swap_b32 v17, v16
    v_max_f32 v16, v16, v17
    v_and_b32 v17, 0xffff0000, v16
    v_sub_f32 v120, v16, v17
    v_and_b32 v121, 0xffff0000, v120
    v_sub_f32 v120, v120, v121
    v_lshrrev_b32 v17, 16, v17
    s_mov_b32 exec_lo, 0
    v_or_b32 v148, v17, v121
    v_lshrrev_b32 v149, 16, v120
    v_xor_b32 v148, 0x80008000, v148
    v_xor_b32 v149, 0x8000, v149
    s_mov_b32 exec_lo, -1
    s_branch L_atstart
L_op0:
    ds_read_u16 v17, v16
    s_sub_u32 s59, s59, 1
    s_waitcnt lgkmcnt(0)
    v_readfirstlane_b32 s54, v17
    s_cmp_lt_i32 s59, 0
    s_cselect_b32 s54, -1, s54
    s_lshr_b32 s55, s54, 1
    s_and_b32 s54, s54, s55
    s_bitcmp1_b32 s54, 0
    s_cbranch_scc1 L_og0
    s_sleep 1
    s_branch L_op0
L_op1:
    ds_read_u16 v17, v16
    s_sub_u32 s59, s59, 1
    s_waitcnt lgkmcnt(0)
    v_readfirstlane_b32 s54, v17
    s_cmp_lt_i32 s59, 0
    s_cselect_b32 s54, -1, s54
    s_lshr_b32 s55, s54, 1
    s_and_b32 s54, s54, s55
    s_bitcmp1_b32 s54, 2
    s_cbranch_scc1 L_og1
    s_sleep 1
    s_branch L_op1
L_op2:
    ds_read_u16 v17, v16
    s_sub_u32 s59, s59, 1
    s_waitcnt lgkmcnt(0)
    v_readfirstlane_b32 s54, v17
    s_cmp_lt_i32 s59, 0
    s_cselect_b32 s54, -1, s54
    s_lshr_b32 s55, s54, 1
    s_and_b32 s54, s54, s55
    s_bitcmp1_b32 s54, 4
    s_cbranch_scc1 L_og2
    s_sleep 1
    s_branch L_op2
L_op3:
    ds_read_u16 v17, v16
    s_sub_u32 s59, s59, 1
    s_waitcnt lgkmcnt(0)
    v_readfirstlane_b32 s54, v17
    s_cmp_lt_i32 s59, 0
    s_cselect_b32 s54, -1, s54
    s_lshr_b32 s55, s54, 1
    s_and_b32 s54, s54, s55
    s_bitcmp1_b32 s54, 6
    s_cbranch_scc1 L_og3
    s_sleep 1
    s_branch L_op3
L_op4:
    ds_read_u16 v17, v16
    s_sub_u32 s59, s59, 1
    s_waitcnt lgkmcnt(0)
    v_readfirstlane_b32 s54, v17
    s_cmp_lt_i32 s59, 0
    s_cselect_b32 s54, -1, s54
    s_lshr_b32 s55, s54, 1
    s_and_b32 s54, s54, s55
    s_bitcmp1_b32 s54, 8
    s_cbranch_scc1 L_og4
    s_sleep 1
    s_branch L_op4
L_op5:
    ds_read_u16 v17, v16
    s_sub_u32 s59, s59, 1
    s_waitcnt lgkmcnt(0)
    v_readfirstlane_b32 s54, v17
    s_cmp_lt_i32 s59, 0
    s_cselect_b32 s54, -1, s54
    s_lshr_b32 s55, s54, 1
    s_and_b32 s54, s54, s55
    s_bitcmp1_b32 s54, 10
    s_cbranch_scc1 L_og5
    s_sleep 1
    s_branch L_op5
L_op6:
    ds_read_u16 v17, v16
    s_sub_u32 s59, s59, 1
    s_waitcnt lgkmcnt(0)
    v_readfirstlane_b32 s54, v17
    s_cmp_lt_i32 s59, 0
    s_cselect_b32 s54, -1, s54
    s_lshr_b32 s55, s54, 1
    s_and_b32 s54, s54, s55
    s_bitcmp1_b32 s54, 12
    s_cbranch_scc1 L_og6
    s_sleep 1
    s_branch L_op6
L_op7:
    ds_read_u16 v17, v16
    s_sub_u32 s59, s59, 1
    s_waitcnt lgkmcnt(0)
    v_readfirstlane_b32 s54, v17
    s_cmp_lt_i32 s59, 0
    s_cselect_b32 s54, -1, s54
    s_lshr_b32 s55, s54, 1
    s_and_b32 s54, s54, s55
    s_bitcmp1_b32 s54, 14
    s_cbranch_scc1 L_og7
    s_sleep 1
    s_branch L_op7
L_codeend:
    s_endpgm
.section .rodata,"a"
.p2align 6
.amdhsa_kernel concat_heads__sliding_block__ssm_conv_h3__prompt_kernel
  .amdhsa_next_free_vgpr 168
  .amdhsa_next_free_sgpr 102
  .amdhsa_accum_offset 168
  .amdhsa_group_segment_fixed_size 0
  .amdhsa_kernarg_size 96
  .amdhsa_user_sgpr_count 2
  .amdhsa_user_sgpr_kernarg_segment_ptr 1
  .amdhsa_system_sgpr_workgroup_id_x 1
.end_amdhsa_kernel
```
